```python
import torch

def _softmax(x, axis=-1):
    return torch.softmax(x, dim=axis)
def _gelu(x):
    return torch.nn.functional.gelu(x, approximate="tanh")
def _silu(x):
    return torch.nn.functional.silu(x)
def _sigmoid(x):
    return torch.sigmoid(x)
def _layernorm(x, axis=-1, eps=1e-5):
    m = x.mean(dim=axis, keepdim=True)
    v = x.var(dim=axis, keepdim=True, unbiased=False)
    return (x - m) / torch.sqrt(v + eps)
def _scatter_add(tgt, idx, src, axis=0):
    return tgt.clone().index_add_(axis, idx, src)
def _segment_sum(src, seg, n):
    out = torch.zeros((n,) + src.shape[1:], dtype=src.dtype)
    return out.index_add_(0, seg, src)
def _pad(x, pw):
    flat = tuple(v for pair in reversed(pw) for v in pair)
    return torch.nn.functional.pad(x, flat)

kernel_name = 'interleave_layers__ssm_conv_h3__glu_gated_geglu__prompt'

def setup_inputs():

    _w = (lambda a: (lambda t: t.to(torch.bfloat16) if t.is_floating_point() else t)(torch.as_tensor(a)))
    def _A_setup():
        B, S, D = 1, 2048, 512
        ks = 4
        return {
            "q": _w((lambda *s: torch.randn(*s, dtype=torch.bfloat16) * 0.05)(B, S, D)),
            "k": _w((lambda *s: torch.randn(*s, dtype=torch.bfloat16) * 0.2)(B, S, D)),
            "v": _w((lambda *s: torch.randn(*s, dtype=torch.bfloat16) * 0.2)(B, S, D)),
            "shift_k": _w((lambda *s: torch.randn(*s, dtype=torch.bfloat16) * 0.2)(D, ks) * 0.5),
            "ssm_k": _w((lambda *s: torch.randn(*s, dtype=torch.bfloat16) * 0.4)(D, S) * (1.0 / S ** 0.5)),
            "ssm_D": _w((lambda *s: torch.randn(*s, dtype=torch.bfloat16) * 0.2)(D)),
        }
    _A_in = _A_setup()

    def _B_setup():
        B, S, Dm, Df = 1, 2048, 512, 1792
        return {
            "x": _w((lambda *s: torch.randn(*s, dtype=torch.bfloat16) * 0.05)(B, S, Dm)),
            "w_gate": _w((lambda *s: torch.randn(*s, dtype=torch.bfloat16) * 0.4)(Dm, Df) * (Dm ** -0.5)),
            "w_up": _w((lambda *s: torch.randn(*s, dtype=torch.bfloat16) * 0.4)(Dm, Df) * (Dm ** -0.5)),
            "w_down": _w((lambda *s: torch.randn(*s, dtype=torch.bfloat16) * 0.4)(Df, Dm) * (Df ** -0.5)),
        }
    _B_in = _B_setup()

    return {
        "A_q": _A_in["q"],
        "A_k": _A_in["k"],
        "A_v": _A_in["v"],
        "A_shift_k": _A_in["shift_k"],
        "A_ssm_k": _A_in["ssm_k"],
        "A_ssm_D": _A_in["ssm_D"],
        "B_x": _B_in["x"],
        "B_w_gate": _B_in["w_gate"],
        "B_w_up": _B_in["w_up"],
        "B_w_down": _B_in["w_down"],
    }

def reference(A_q, A_k, A_v, A_shift_k, A_ssm_k, A_ssm_D, B_x, B_w_gate, B_w_up, B_w_down):
    def _A_ref(q, k, v, shift_k, ssm_k, ssm_D):
        B, S, D = q.shape
        ks = shift_k.shape[-1]
        k_pad = _pad(k, ((0, 0), (ks - 1, 0), (0, 0)))
        k_shift = torch.zeros_like(k)
        for t in range(ks):
            k_shift = k_shift + k_pad[:, t:t + S, :] * shift_k[:, ks - 1 - t][None, None, :]
        kv = k_shift * v
        L = 2 * S
        kv_pad = _pad(kv, ((0, 0), (0, S), (0, 0)))
        kf_pad = _pad(ssm_k, ((0, 0), (0, S)))
        kv_f = (lambda x, axes=(-2,-1): torch.fft.rfft2(x.float(), dim=axes))(kv_pad[:, None, :, :], axes=(1, 2))
        kf_f = (lambda x, axes=(-2,-1): torch.fft.rfft2(x.float(), dim=axes))(kf_pad[:, None, :], axes=(1, 2))
        kf_f = (lambda x, *d: x.permute(*d))(kf_f, 1, 2, 0)
        y_f = kv_f * kf_f[None, :, :, :]
        y = (lambda x, s, axes=(-2,-1): torch.fft.irfft2(x, s=s, dim=axes).to(torch.bfloat16))(y_f, (1, L), axes=(1, 2))[:, 0, :S, :]
        y = y + kv * ssm_D[None, None, :]
        return q * y

    def _B_ref(x, w_gate, w_up, w_down):
        g = torch.einsum("bsd,df->bsf", x, w_gate)
        u = torch.einsum("bsd,df->bsf", x, w_up)
        h = _gelu(g) * u
        return torch.einsum("bsf,fd->bsd", h, w_down)

    x = A_q
    x = x + _A_ref(_layernorm(x, axis=-1), A_k, A_v, A_shift_k, A_ssm_k, A_ssm_D)
    x = x + _B_ref(_layernorm(x, axis=-1), B_w_gate, B_w_up, B_w_down)
    x = x + _A_ref(_layernorm(x, axis=-1), A_k, A_v, A_shift_k, A_ssm_k, A_ssm_D)
    x = x + _B_ref(_layernorm(x, axis=-1), B_w_gate, B_w_up, B_w_down)
    return x
```

```asm
; @launch grid=(256,1,1) block=(256,1,1) lds=163840
.amdgcn_target "amdgcn-amd-amdhsa--gfx950"
.text
.globl interleave_layers__ssm_conv_h3__glu_gated_geglu__prompt_kernel
.p2align 8
.type interleave_layers__ssm_conv_h3__glu_gated_geglu__prompt_kernel,@function
interleave_layers__ssm_conv_h3__glu_gated_geglu__prompt_kernel:
    s_cmp_ge_u32 s2, 256
    s_cbranch_scc1 L_end
    v_and_b32 v75, 63, v0
    v_lshlrev_b32 v75, 3, v75
    s_mov_b64 exec, 0x1fff
    global_load_dwordx2 v[76:77], v75, s[0:1]
    s_mov_b64 exec, -1
    s_load_dwordx2 s[8:9], s[0:1], 8
    s_load_dwordx2 s[12:13], s[0:1], 16
    s_load_dwordx2 s[16:17], s[0:1], 24
    s_load_dwordx2 s[20:21], s[0:1], 32
    s_load_dwordx2 s[4:5], s[0:1], 0
    s_load_dwordx2 s[24:25], s[0:1], 56
    s_load_dwordx2 s[28:29], s[0:1], 64
    s_load_dwordx2 s[32:33], s[0:1], 72
    s_load_dwordx2 s[36:37], s[0:1], 80
    s_load_dwordx2 s[40:41], s[0:1], 96
    s_load_dwordx2 s[44:45], s[0:1], 88
    s_load_dwordx2 s[52:53], s[0:1], 40
    v_and_b32 v1, 63, v0
    v_lshrrev_b32 v2, 6, v0
    s_and_b32 s48, s2, 7
    s_lshr_b32 s49, s2, 3
    v_readfirstlane_b32 s50, v2
    s_getpc_b64 s[96:97]
L_pc0:
    v_lshlrev_b32 v3, 3, v2
    v_add_u32 v3, s49, v3
    v_and_b32 v3, 31, v3
    v_lshlrev_b32 v3, 10, v3
    v_lshlrev_b32 v4, 4, v1
    v_add_u32 v3, v3, v4
    v_min_u32 v3, (L_code_end - L_pc0 - 16), v3
    global_load_dwordx4 v[12:15], v3, s[96:97]
    s_mov_b32 s10, 2097152
    s_mov_b32 s11, 0x20000
    s_mov_b32 s14, 2097152
    s_mov_b32 s15, 0x20000
    s_mov_b32 s18, 4096
    s_mov_b32 s19, 0x20000
    s_mov_b32 s42, 33554432
    s_mov_b32 s43, 0x20000
    v_lshrrev_b32 v4, 4, v0
    v_and_b32 v5, 15, v0
    s_lshl_b32 s54, s49, 16
    s_lshl_b32 s55, s48, 7
    s_add_u32 s54, s54, s55
    v_lshlrev_b32 v6, 12, v4
    v_lshlrev_b32 v2, 3, v5
    v_add_u32 v6, v6, v2
    v_add_u32 v6, s54, v6
    v_subrev_u32 v7, 3072, v6
    v_subrev_u32 v8, 2048, v6
    v_subrev_u32 v9, 1024, v6
    v_lshlrev_b32 v2, 5, v5
    s_lshl_b32 s55, s48, 9
    v_add_u32 v2, s55, v2
    s_waitcnt lgkmcnt(0)
    s_waitcnt vmcnt(1)
    s_mov_b64 exec, 0x1fff
    global_load_dword v78, v[76:77], off
    s_mov_b64 exec, -1
    s_or_b32 s55, s2, s50
    s_cmp_lg_u32 s55, 0
    s_cbranch_scc1 L_z_1
    v_lshlrev_b32 v11, 8, v1
    v_mov_b32 v3, 0
    s_mov_b32 s55, 0
    buffer_store_dword v3, v11, s[40:43], s55 offen sc1
    s_mov_b32 s55, 16384
    buffer_store_dword v3, v11, s[40:43], s55 offen sc1
    s_mov_b32 s55, 32768
    buffer_store_dword v3, v11, s[40:43], s55 offen sc1
    s_mov_b32 s55, 49152
    buffer_store_dword v3, v11, s[40:43], s55 offen sc1
L_z_1:
    buffer_load_dwordx2 v[16:17], v7, s[8:11], 0 offen
    buffer_load_dwordx2 v[18:19], v8, s[8:11], 0 offen
    buffer_load_dwordx2 v[20:21], v9, s[8:11], 0 offen
    buffer_load_dwordx2 v[22:23], v6, s[8:11], 0 offen offset:0
    buffer_load_dwordx2 v[24:25], v6, s[8:11], 0 offen offset:1024
    buffer_load_dwordx2 v[26:27], v6, s[8:11], 0 offen offset:2048
    buffer_load_dwordx2 v[28:29], v6, s[8:11], 0 offen offset:3072
    buffer_load_dwordx2 v[30:31], v6, s[12:15], 0 offen offset:0
    buffer_load_dwordx2 v[32:33], v6, s[12:15], 0 offen offset:1024
    buffer_load_dwordx2 v[34:35], v6, s[12:15], 0 offen offset:2048
    buffer_load_dwordx2 v[36:37], v6, s[12:15], 0 offen offset:3072
    buffer_load_dwordx4 v[40:43], v2, s[16:19], 0 offen
    buffer_load_dwordx4 v[44:47], v2, s[16:19], 0 offen offset:16
    v_lshlrev_b32 v2, 21, v1
    s_mov_b32 s55, 0x10040
    s_mov_b64 exec, 0xffff
    buffer_load_dword v13, v2, s[40:43], s55 offen sc1
    s_mov_b64 exec, -1
    s_or_b32 s55, s2, s50
    s_cmp_lg_u32 s55, 0
    s_cbranch_scc1 L_z_2
    s_mov_b32 s46, 256
    s_mov_b32 s47, 0x20000
    s_waitcnt vmcnt(14)
    s_mov_b64 exec, 1
    v_mov_b32 v2, 0
    v_mov_b32 v3, 1
    buffer_store_dword v3, v2, s[44:47], 0 offen sc1
    s_mov_b64 exec, -1
L_z_2:
    s_mov_b32 s6, 2097152
    s_mov_b32 s7, 0x20000
    s_mov_b32 s22, 2097152
    s_mov_b32 s23, 0x20000
    s_mov_b32 s26, 1835008
    s_mov_b32 s27, 0x20000
    s_mov_b32 s30, 1835008
    s_mov_b32 s31, 0x20000
    s_mov_b32 s34, 1835008
    s_mov_b32 s35, 0x20000
    s_mov_b32 s38, 2097152
    s_mov_b32 s39, 0x20000
    s_mov_b32 s46, 256
    s_mov_b32 s47, 0x20000
    s_lshl_b32 s51, s48, 5
    s_add_u32 s51, s51, s49
    s_lshr_b32 s54, s49, 3
    s_lshl_b32 s61, s48, 2
    s_add_u32 s61, s61, s54
    s_and_b32 s62, s49, 7
    s_lshr_b32 s54, s48, 2
    s_lshl_b32 s54, s54, 3
    s_lshr_b32 s55, s49, 2
    s_add_u32 s65, s54, s55
    s_and_b32 s54, s48, 3
    s_lshl_b32 s54, s54, 2
    s_and_b32 s55, s49, 3
    s_add_u32 s66, s54, s55
    s_lshr_b32 s54, s50, 1
    s_lshl_b32 s63, s62, 1
    s_add_u32 s63, s63, s54
    s_and_b32 s54, s50, 1
    s_lshl_b32 s64, s61, 1
    s_add_u32 s64, s64, s54
    s_lshl_b32 s72, s65, 2
    s_add_u32 s72, s72, s50
    s_lshl_b32 s54, s51, 2
    s_load_dword s59, s[52:53], s54
    v_lshlrev_b32 v2, 4, v0
    s_lshl_b32 s55, s51, 13
    v_add_u32 v3, s55, v2
    v_subrev_u32 v8, 16, v3
    v_add_u32 v9, 0x1000, v8
    v_cmp_eq_u32 vcc, 0, v0
    v_mov_b32 v10, 0x80000000
    s_nop 0
    v_cndmask_b32 v8, v8, v10, vcc
    v_cndmask_b32 v9, v9, v10, vcc
    buffer_load_dwordx4 v[48:51], v8, s[20:23], 0 offen
    buffer_load_dwordx4 v[52:55], v3, s[20:23], 0 offen
    buffer_load_dwordx4 v[56:59], v9, s[20:23], 0 offen
    s_mov_b32 s55, 0x1000
    buffer_load_dwordx4 v[60:63], v3, s[20:23], s55 offen
    v_and_b32 v2, 31, v1
    v_lshlrev_b32 v2, 10, v2
    v_lshrrev_b32 v3, 5, v1
    v_lshlrev_b32 v3, 4, v3
    v_add_u32 v2, v2, v3
    s_lshl_b32 s55, s64, 15
    s_lshl_b32 s56, s63, 6
    s_add_u32 s55, s55, s56
    buffer_load_dwordx4 v[64:67], v2, s[4:7], s55 offen
    buffer_load_dwordx4 v[68:71], v2, s[4:7], s55 offen offset:32
    s_cmp_ge_u32 s2, 224
    s_cbranch_scc1 L_wdma_3
    v_lshrrev_b32 v2, 3, v1
    v_mul_u32_u24 v2, 3584, v2
    v_and_b32 v3, 7, v1
    v_lshlrev_b32 v3, 4, v3
    v_add_u32 v2, v2, v3
    s_mul_i32 s55, s48, 229376
    s_lshl_b32 s56, s49, 7
    s_add_u32 s55, s55, s56
    s_mul_i32 s56, s50, 57344
    s_add_u32 s55, s55, s56
    s_lshl_b32 s56, s50, 11
    s_add_u32 m0, s56, 98304
    s_add_u32 s57, s55, 0
    buffer_load_dwordx4 v2, s[24:27], s57 offen lds
    s_add_u32 m0, s56, 99328
    s_add_u32 s57, s55, 28672
    buffer_load_dwordx4 v2, s[24:27], s57 offen lds
    s_add_u32 m0, s56, 106496
    s_add_u32 s57, s55, 0
    buffer_load_dwordx4 v2, s[28:31], s57 offen lds
    s_add_u32 m0, s56, 107520
    s_add_u32 s57, s55, 28672
    buffer_load_dwordx4 v2, s[28:31], s57 offen lds
    v_lshrrev_b32 v2, 3, v1
    v_lshlrev_b32 v2, 10, v2
    v_add_u32 v2, v2, v3
    s_lshl_b32 s55, s49, 16
    s_lshl_b32 s57, s48, 7
    s_add_u32 s55, s55, s57
    s_lshl_b32 s57, s50, 14
    s_add_u32 s55, s55, s57
    s_add_u32 m0, s56, 114688
    s_add_u32 s57, s55, 0
    buffer_load_dwordx4 v2, s[32:35], s57 offen lds
    s_add_u32 m0, s56, 115712
    s_add_u32 s57, s55, 8192
    buffer_load_dwordx4 v2, s[32:35], s57 offen lds
L_wdma_3:
    s_cmp_ge_u32 s2, 224
    s_cbranch_scc1 L_w_4
    s_waitcnt vmcnt(13)
    s_branch L_w_5
L_w_4:
    s_waitcnt vmcnt(7)
L_w_5:
    v_lshlrev_b32 v108, 16, v40
    v_and_b32 v112, 0xffff0000, v40
    v_lshlrev_b32 v116, 16, v41
    v_and_b32 v120, 0xffff0000, v41
    v_lshlrev_b32 v109, 16, v42
    v_and_b32 v113, 0xffff0000, v42
    v_lshlrev_b32 v117, 16, v43
    v_and_b32 v121, 0xffff0000, v43
    v_lshlrev_b32 v110, 16, v44
    v_and_b32 v114, 0xffff0000, v44
    v_lshlrev_b32 v118, 16, v45
    v_and_b32 v122, 0xffff0000, v45
    v_lshlrev_b32 v111, 16, v46
    v_and_b32 v115, 0xffff0000, v46
    v_lshlrev_b32 v119, 16, v47
    v_and_b32 v123, 0xffff0000, v47
    v_lshlrev_b32 v80, 16, v16
    v_and_b32 v81, 0xffff0000, v16
    v_lshlrev_b32 v82, 16, v17
    v_and_b32 v83, 0xffff0000, v17
    v_lshlrev_b32 v84, 16, v18
    v_and_b32 v85, 0xffff0000, v18
    v_lshlrev_b32 v86, 16, v19
    v_and_b32 v87, 0xffff0000, v19
    v_lshlrev_b32 v88, 16, v20
    v_and_b32 v89, 0xffff0000, v20
    v_lshlrev_b32 v90, 16, v21
    v_and_b32 v91, 0xffff0000, v21
    v_lshlrev_b32 v92, 16, v22
    v_and_b32 v93, 0xffff0000, v22
    v_lshlrev_b32 v94, 16, v23
    v_and_b32 v95, 0xffff0000, v23
    v_lshlrev_b32 v96, 16, v24
    v_and_b32 v97, 0xffff0000, v24
    v_lshlrev_b32 v98, 16, v25
    v_and_b32 v99, 0xffff0000, v25
    v_lshlrev_b32 v100, 16, v26
    v_and_b32 v101, 0xffff0000, v26
    v_lshlrev_b32 v102, 16, v27
    v_and_b32 v103, 0xffff0000, v27
    v_lshlrev_b32 v104, 16, v28
    v_and_b32 v105, 0xffff0000, v28
    v_lshlrev_b32 v106, 16, v29
    v_and_b32 v107, 0xffff0000, v29
    v_lshlrev_b32 v124, 16, v30
    v_and_b32 v125, 0xffff0000, v30
    v_lshlrev_b32 v126, 16, v31
    v_and_b32 v127, 0xffff0000, v31
    v_lshlrev_b32 v128, 16, v32
    v_and_b32 v129, 0xffff0000, v32
    v_lshlrev_b32 v130, 16, v33
    v_and_b32 v131, 0xffff0000, v33
    v_lshlrev_b32 v132, 16, v34
    v_and_b32 v133, 0xffff0000, v34
    v_lshlrev_b32 v134, 16, v35
    v_and_b32 v135, 0xffff0000, v35
    v_lshlrev_b32 v136, 16, v36
    v_and_b32 v137, 0xffff0000, v36
    v_lshlrev_b32 v138, 16, v37
    v_and_b32 v139, 0xffff0000, v37
    v_pk_mul_f32 v[140:141], v[80:81], v[120:121]
    v_pk_mul_f32 v[142:143], v[82:83], v[122:123]
    v_pk_mul_f32 v[144:145], v[84:85], v[120:121]
    v_pk_mul_f32 v[146:147], v[86:87], v[122:123]
    v_pk_mul_f32 v[148:149], v[88:89], v[120:121]
    v_pk_mul_f32 v[150:151], v[90:91], v[122:123]
    v_pk_mul_f32 v[152:153], v[92:93], v[120:121]
    v_pk_mul_f32 v[154:155], v[94:95], v[122:123]
    v_pk_fma_f32 v[140:141], v[84:85], v[116:117], v[140:141]
    v_pk_fma_f32 v[142:143], v[86:87], v[118:119], v[142:143]
    v_pk_fma_f32 v[144:145], v[88:89], v[116:117], v[144:145]
    v_pk_fma_f32 v[146:147], v[90:91], v[118:119], v[146:147]
    v_pk_fma_f32 v[148:149], v[92:93], v[116:117], v[148:149]
    v_pk_fma_f32 v[150:151], v[94:95], v[118:119], v[150:151]
    v_pk_fma_f32 v[152:153], v[96:97], v[116:117], v[152:153]
    v_pk_fma_f32 v[154:155], v[98:99], v[118:119], v[154:155]
    v_pk_fma_f32 v[140:141], v[88:89], v[112:113], v[140:141]
    v_pk_fma_f32 v[142:143], v[90:91], v[114:115], v[142:143]
    v_pk_fma_f32 v[144:145], v[92:93], v[112:113], v[144:145]
    v_pk_fma_f32 v[146:147], v[94:95], v[114:115], v[146:147]
    v_pk_fma_f32 v[148:149], v[96:97], v[112:113], v[148:149]
    v_pk_fma_f32 v[150:151], v[98:99], v[114:115], v[150:151]
    v_pk_fma_f32 v[152:153], v[100:101], v[112:113], v[152:153]
    v_pk_fma_f32 v[154:155], v[102:103], v[114:115], v[154:155]
    v_pk_fma_f32 v[140:141], v[92:93], v[108:109], v[140:141]
    v_pk_fma_f32 v[142:143], v[94:95], v[110:111], v[142:143]
    v_pk_fma_f32 v[144:145], v[96:97], v[108:109], v[144:145]
    v_pk_fma_f32 v[146:147], v[98:99], v[110:111], v[146:147]
    v_pk_fma_f32 v[148:149], v[100:101], v[108:109], v[148:149]
    v_pk_fma_f32 v[150:151], v[102:103], v[110:111], v[150:151]
    v_pk_fma_f32 v[152:153], v[104:105], v[108:109], v[152:153]
    v_pk_fma_f32 v[154:155], v[106:107], v[110:111], v[154:155]
    v_pk_mul_f32 v[140:141], v[140:141], v[124:125]
    v_pk_mul_f32 v[142:143], v[142:143], v[126:127]
    v_pk_mul_f32 v[144:145], v[144:145], v[128:129]
    v_pk_mul_f32 v[146:147], v[146:147], v[130:131]
    v_pk_mul_f32 v[148:149], v[148:149], v[132:133]
    v_pk_mul_f32 v[150:151], v[150:151], v[134:135]
    v_pk_mul_f32 v[152:153], v[152:153], v[136:137]
    v_pk_mul_f32 v[154:155], v[154:155], v[138:139]
    v_cvt_pk_bf16_f32 v160, v152, v148
    v_cvt_pk_bf16_f32 v161, v144, v140
    v_cvt_pk_bf16_f32 v162, v153, v149
    v_cvt_pk_bf16_f32 v163, v145, v141
    v_cvt_pk_bf16_f32 v164, v154, v150
    v_cvt_pk_bf16_f32 v165, v146, v142
    v_cvt_pk_bf16_f32 v166, v155, v151
    v_cvt_pk_bf16_f32 v167, v147, v143
    v_mul_u32_u24 v2, 576, v5
    v_lshlrev_b32 v3, 3, v4
    v_sub_u32 v2, v2, v3
    v_add_u32 v2, 88952, v2
    ds_write_b64 v2, v[160:161] offset:0
    ds_write_b64 v2, v[162:163] offset:144
    ds_write_b64 v2, v[164:165] offset:288
    ds_write_b64 v2, v[166:167] offset:432
    v_lshrrev_b32 v2, 3, v0
    v_and_b32 v3, 7, v0
    v_lshlrev_b32 v3, 4, v3
    v_mul_u32_u24 v8, 144, v2
    v_add_u32 v8, v8, v3
    v_add_u32 v8, 88832, v8
    v_lshlrev_b32 v2, 12, v2
    v_add_u32 v2, v2, v3
    s_lshl_b32 s55, s48, 18
    s_sub_u32 s56, 31, s49
    s_lshl_b32 s56, s56, 7
    s_add_u32 s55, s55, s56
    s_add_u32 s55, s55, 65536
    s_add_u32 s56, s55, 131072
    s_waitcnt lgkmcnt(0)
    s_barrier
    ds_read_b128 v[160:163], v8
    ds_read_b128 v[164:167], v8 offset:4608
    s_waitcnt lgkmcnt(0)
    v_mov_b32 v11, 0
    buffer_load_dword v12, v11, s[44:47], 0 offen sc1
    buffer_store_dwordx4 v[160:163], v2, s[40:43], s55 offen sc1
    buffer_store_dwordx4 v[164:167], v2, s[40:43], s56 offen sc1
    s_waitcnt vmcnt(0)
    s_barrier
    s_cmp_lg_u32 s50, 0
    s_cbranch_scc1 L_arr_6
    s_mov_b64 exec, 1
    v_readfirstlane_b32 s52, v12
    s_nop 0
    s_cmp_eq_u32 s52, 1
    s_cbranch_scc1 L_iok_7
    v_mov_b32 v2, 0
    s_mov_b32 s60, 0
L_sp_8:
    buffer_load_dword v3, v2, s[44:47], 0 offen sc1
    s_waitcnt vmcnt(0)
    s_add_u32 s60, s60, 1
    v_readfirstlane_b32 s52, v3
    s_nop 0
    s_cmp_eq_u32 s52, 1
    s_cbranch_scc1 L_spok_9
    s_cmp_lt_u32 s60, 20000
    s_cbranch_scc1 L_sp_8
L_spok_9:
L_iok_7:
    s_lshl_b32 s52, s48, 8
    v_mov_b32 v2, s52
    v_mov_b32 v3, 1
    buffer_atomic_add v3, v2, s[40:43], 0 offen sc1
    s_mov_b64 exec, -1
L_arr_6:
    v_lshlrev_b32 v2, 4, v0
    v_add_u32 v2, 128, v2
    v_mov_b32 v80, v49
    v_mov_b32 v81, v50
    v_mov_b32 v82, v51
    v_mov_b32 v83, v52
    v_mov_b32 v84, v53
    v_mov_b32 v85, v54
    v_alignbyte_b32 v88, v49, v48, 2
    v_alignbyte_b32 v89, v50, v49, 2
    v_alignbyte_b32 v90, v51, v50, 2
    v_alignbyte_b32 v91, v52, v51, 2
    v_alignbyte_b32 v92, v53, v52, 2
    v_alignbyte_b32 v93, v54, v53, 2
    v_alignbyte_b32 v94, v55, v54, 2
    v_alignbyte_b32 v96, v50, v49, 2
    v_alignbyte_b32 v97, v51, v50, 2
    v_alignbyte_b32 v98, v52, v51, 2
    v_alignbyte_b32 v99, v53, v52, 2
    v_alignbyte_b32 v100, v54, v53, 2
    v_alignbyte_b32 v101, v55, v54, 2
    ds_write_b128 v2, v[52:55] offset:0
    ds_write_b128 v2, v[98:101] offset:4416
    ds_write_b128 v2, v[82:85] offset:8832
    ds_write_b128 v2, v[90:93] offset:13248
    ds_write_b128 v2, v[50:53] offset:17664
    ds_write_b128 v2, v[96:99] offset:22080
    ds_write_b128 v2, v[80:83] offset:26496
    ds_write_b128 v2, v[88:91] offset:30912
    v_mov_b32 v80, v57
    v_mov_b32 v81, v58
    v_mov_b32 v82, v59
    v_mov_b32 v83, v60
    v_mov_b32 v84, v61
    v_mov_b32 v85, v62
    v_alignbyte_b32 v88, v57, v56, 2
    v_alignbyte_b32 v89, v58, v57, 2
    v_alignbyte_b32 v90, v59, v58, 2
    v_alignbyte_b32 v91, v60, v59, 2
    v_alignbyte_b32 v92, v61, v60, 2
    v_alignbyte_b32 v93, v62, v61, 2
    v_alignbyte_b32 v94, v63, v62, 2
    v_alignbyte_b32 v96, v58, v57, 2
    v_alignbyte_b32 v97, v59, v58, 2
    v_alignbyte_b32 v98, v60, v59, 2
    v_alignbyte_b32 v99, v61, v60, 2
    v_alignbyte_b32 v100, v62, v61, 2
    v_alignbyte_b32 v101, v63, v62, 2
    ds_write_b128 v2, v[60:63] offset:35328
    ds_write_b128 v2, v[98:101] offset:39744
    ds_write_b128 v2, v[82:85] offset:44160
    ds_write_b128 v2, v[90:93] offset:48576
    ds_write_b128 v2, v[58:61] offset:52992
    ds_write_b128 v2, v[96:99] offset:57408
    ds_write_b128 v2, v[80:83] offset:61824
    v_add_u32 v3, 66240, v2
    ds_write_b128 v3, v[88:91]
    v_mov_b32 v104, 0
    v_mov_b32 v105, 0
    v_mov_b32 v106, 0
    v_mov_b32 v107, 0
    v_lshrrev_b32 v2, 3, v1
    v_mul_u32_u24 v2, 4416, v2
    v_and_b32 v3, 7, v1
    v_lshlrev_b32 v3, 4, v3
    v_add_u32 v2, v2, v3
    s_and_b32 s55, s50, 1
    s_mul_i32 s55, s55, 35328
    v_add_u32 v2, s55, v2
    ds_write_b128 v2, v[104:107]
    s_lshr_b32 s55, s50, 1
    s_mul_i32 s55, s55, 9072
    s_and_b32 s56, s50, 1
    s_lshl_b32 s56, s56, 10
    s_add_u32 s55, s55, s56
    s_add_u32 s55, s55, 75264
    v_lshlrev_b32 v2, 4, v1
    v_add_u32 v2, s55, v2
    ds_write_b128 v2, v[104:107]
    ds_write_b128 v2, v[104:107] offset:2048
    v_cmp_gt_u32 vcc, 23, v1
    s_and_b32 s56, s50, 1
    s_cmp_eq_u32 s56, 0
    s_cselect_b64 s[52:53], -1, 0
    s_and_b64 vcc, vcc, s[52:53]
    s_and_saveexec_b64 s[54:55], vcc
    s_cbranch_execz L_z3_10
    ds_write_b128 v2, v[104:107] offset:4096
L_z3_10:
    s_mov_b64 exec, -1
    s_cmp_lg_u32 s50, 0
    s_cbranch_scc1 L_ap_11
    s_mov_b64 exec, 1
    s_lshl_b32 s52, s48, 8
    v_mov_b32 v2, s52
    buffer_load_dword v13, v2, s[40:43], 0 offen sc1
    s_mov_b64 exec, -1
L_ap_11:
    v_mov_b32 v10, 0x3f803f80
    v_mov_b32 v8, 0
    v_mov_b32 v9, 0
    v_dot2_f32_bf16 v8, v64, v10, v8
    v_dot2_f32_bf16 v9, v64, v64, v9
    v_dot2_f32_bf16 v8, v65, v10, v8
    v_dot2_f32_bf16 v9, v65, v65, v9
    v_dot2_f32_bf16 v8, v66, v10, v8
    v_dot2_f32_bf16 v9, v66, v66, v9
    v_dot2_f32_bf16 v8, v67, v10, v8
    v_dot2_f32_bf16 v9, v67, v67, v9
    v_dot2_f32_bf16 v8, v68, v10, v8
    v_dot2_f32_bf16 v9, v68, v68, v9
    v_dot2_f32_bf16 v8, v69, v10, v8
    v_dot2_f32_bf16 v9, v69, v69, v9
    v_dot2_f32_bf16 v8, v70, v10, v8
    v_dot2_f32_bf16 v9, v70, v70, v9
    v_dot2_f32_bf16 v8, v71, v10, v8
    v_dot2_f32_bf16 v9, v71, v71, v9
    v_lshrrev_b32 v3, 3, v0
    v_mul_u32_u24 v3, 144, v3
    v_and_b32 v4, 7, v0
    v_lshlrev_b32 v4, 4, v4
    v_add_u32 v3, v3, v4
    v_add_u32 v228, 70656, v3
    v_and_b32 v2, 31, v1
    v_lshrrev_b32 v7, 5, v1
    s_lshr_b32 s55, s50, 1
    s_and_b32 s56, s50, 1
    v_sub_u32 v4, 31, v2
    v_mul_u32_u24 v4, 144, v4
    v_lshlrev_b32 v5, 4, v7
    v_add_u32 v4, v4, v5
    s_mul_i32 s57, s55, 9072
    s_mul_i32 s54, s56, 1728
    s_add_u32 s57, s57, s54
    s_add_u32 s57, s57, 70656
    v_add_u32 v224, s57, v4
    v_and_b32 v4, 7, v2
    v_mul_u32_u24 v4, 4416, v4
    v_add_u32 v4, v4, v5
    v_lshrrev_b32 v6, 3, v2
    v_lshlrev_b32 v6, 4, v6
    v_sub_u32 v4, v4, v6
    s_mul_i32 s57, s55, 35328
    s_mul_i32 s54, s56, 1536
    s_add_u32 s57, s57, s54
    s_add_u32 s57, s57, 64
    v_add_u32 v225, s57, v4
    v_sub_u32 v4, 31, v2
    v_mul_u32_u24 v4, 80, v4
    v_lshlrev_b32 v6, 4, v7
    v_add_u32 v4, v4, v6
    s_lshl_b32 s57, s55, 14
    s_add_u32 s57, s57, 131072
    v_add_u32 v226, s57, v4
    v_add_u32 v6, 3200, v6
    v_add_u32 v6, s57, v6
    v_and_b32 v4, 1, v2
    v_cmp_eq_u32 vcc, 1, v4
    s_nop 1
    v_cndmask_b32 v227, v226, v6, vcc
    v_lshlrev_b32 v4, 3, v0
    v_subrev_u32 v4, 992, v4
    v_lshrrev_b32 v6, 5, v4
    v_mul_u32_u24 v6, 80, v6
    v_and_b32 v4, 31, v4
    v_lshlrev_b32 v4, 1, v4
    v_add_u32 v229, v6, v4
    v_add_u32 v229, 131072, v229
    v_lshlrev_b32 v15, 4, v0
    v_add_u32 v15, 133712, v15
    v_mov_b32 v16, 0
    v_mov_b32 v17, 0
    v_mov_b32 v18, 0
    v_mov_b32 v19, 0
    v_mov_b32 v20, 0
    v_mov_b32 v21, 0
    v_mov_b32 v22, 0
    v_mov_b32 v23, 0
    v_mov_b32 v24, 0
    v_mov_b32 v25, 0
    v_mov_b32 v26, 0
    v_mov_b32 v27, 0
    v_mov_b32 v28, 0
    v_mov_b32 v29, 0
    v_mov_b32 v30, 0
    v_mov_b32 v31, 0
    v_mov_b32 v32, 0
    v_mov_b32 v33, 0
    v_mov_b32 v34, 0
    v_mov_b32 v35, 0
    v_mov_b32 v36, 0
    v_mov_b32 v37, 0
    v_mov_b32 v38, 0
    v_mov_b32 v39, 0
    v_mov_b32 v40, 0
    v_mov_b32 v41, 0
    v_mov_b32 v42, 0
    v_mov_b32 v43, 0
    v_mov_b32 v44, 0
    v_mov_b32 v45, 0
    v_mov_b32 v46, 0
    v_mov_b32 v47, 0
    v_mov_b32 v144, 0
    v_mov_b32 v145, 0
    v_mov_b32 v146, 0
    v_mov_b32 v147, 0
    v_mov_b32 v148, 0
    v_mov_b32 v149, 0
    v_mov_b32 v150, 0
    v_mov_b32 v151, 0
    v_mov_b32 v152, 0
    v_mov_b32 v153, 0
    v_mov_b32 v154, 0
    v_mov_b32 v155, 0
    v_mov_b32 v156, 0
    v_mov_b32 v157, 0
    v_mov_b32 v158, 0
    v_mov_b32 v159, 0
    v_mov_b32 v48, -1
    v_mov_b32 v49, -1
    v_mov_b32 v50, -1
    v_mov_b32 v51, -1
    v_mov_b32 v52, 0
    v_mov_b32 v53, 0
    v_lshlrev_b32 v54, 4, v0
    v_lshlrev_b32 v55, 4, v1
    v_lshlrev_b32 v56, 3, v1
    v_mov_b32 v120, 0
    v_mov_b32 v121, 0
    v_mov_b32 v122, 0
    v_mov_b32 v123, 0
    v_cmp_gt_u32 vcc, 155, v0
    s_nop 0
    s_and_saveexec_b64 s[52:53], vcc
    ds_write_b128 v15, v[120:123]
    ds_write_b128 v15, v[120:123] offset:16384
    s_mov_b64 exec, s[52:53]
    s_lshl_b32 s73, s51, 13
    s_add_u32 s73, s73, 2162688
    s_lshl_b32 s74, s64, 15
    s_lshl_b32 s56, s63, 11
    s_add_u32 s74, s74, s56
    s_lshl_b32 s76, s63, 14
    s_lshl_b32 s56, s64, 8
    s_add_u32 s76, s76, s56
    s_cmp_lg_u32 s50, 0
    s_cbranch_scc1 L_wt_12
    s_mov_b64 exec, 1
    s_waitcnt vmcnt(0)
    v_cmp_le_u32 vcc, 32, v13
    s_nop 0
    s_cmp_eq_u64 vcc, 1
    s_cbranch_scc1 L_aok_13
    s_lshl_b32 s52, s48, 8
    v_mov_b32 v2, s52
    s_mov_b32 s60, 0
L_sp_14:
    buffer_load_dword v3, v2, s[40:43], 0 offen sc1
    s_waitcnt vmcnt(0)
    s_add_u32 s60, s60, 1
    v_cmp_le_u32 vcc, 32, v3
    s_nop 0
    s_cmp_eq_u64 vcc, 1
    s_cbranch_scc1 L_spok_15
    s_cmp_lt_u32 s60, 20000
    s_cbranch_scc1 L_sp_14
L_spok_15:
L_aok_13:
    s_mov_b64 exec, -1
L_wt_12:
    s_barrier
    v_lshlrev_b32 v2, 4, v0
    s_lshl_b32 s55, s51, 13
    s_add_u32 s55, s55, 65536
    s_add_u32 s56, s55, 4096
    buffer_load_dwordx4 v[112:115], v2, s[40:43], s55 offen sc1
    buffer_load_dwordx4 v[116:119], v2, s[40:43], s56 offen sc1
    v_mov_b32 v11, v8
    v_mov_b32 v12, v9
    v_lshlrev_b32 v2, 3, v1
    s_lshl_b32 s55, s63, 14
    s_lshl_b32 s56, s64, 8
    s_add_u32 s55, s55, s56
    v_permlane32_swap_b32 v8, v11
    v_permlane32_swap_b32 v9, v12
    s_add_u32 s56, s55, 10027008
    v_add_f32 v8, v8, v11
    v_add_f32 v9, v9, v12
    v_or_b32 v9, 1, v9
    s_mov_b64 exec, 0xffffffff
    buffer_store_dwordx2 v[8:9], v2, s[40:43], s56 offen sc1
    s_mov_b64 exec, -1
    s_cmp_ge_u32 s2, 224
    s_cbranch_scc1 L_rp_16
    v_lshrrev_b32 v2, 4, v1
    v_and_b32 v3, 1, v2
    v_lshrrev_b32 v2, 1, v2
    v_lshlrev_b32 v4, 10, v2
    v_bfe_u32 v5, v1, 2, 2
    v_lshlrev_b32 v5, 7, v5
    v_add_u32 v4, v4, v5
    v_and_b32 v5, 1, v1
    v_lshlrev_b32 v5, 4, v5
    v_add_u32 v4, v4, v5
    v_bfe_u32 v5, v1, 1, 1
    v_lshlrev_b32 v5, 3, v5
    v_add_u32 v4, v4, v5
    v_lshlrev_b32 v5, 13, v3
    v_add_u32 v5, v4, v5
    s_lshl_b32 s55, s50, 5
    s_add_u32 s55, s55, 98304
    v_add_u32 v5, s55, v5
    ds_read_b64_tr_b16 v[80:81], v5 offset:0
    ds_read_b64_tr_b16 v[82:83], v5 offset:512
    ds_read_b64_tr_b16 v[84:85], v5 offset:2048
    ds_read_b64_tr_b16 v[86:87], v5 offset:2560
    ds_read_b64_tr_b16 v[88:89], v5 offset:4096
    ds_read_b64_tr_b16 v[90:91], v5 offset:4608
    ds_read_b64_tr_b16 v[92:93], v5 offset:6144
    ds_read_b64_tr_b16 v[94:95], v5 offset:6656
    v_lshlrev_b32 v6, 5, v3
    v_add_u32 v6, v4, v6
    s_and_b32 s55, s50, 1
    s_lshl_b32 s55, s55, 6
    s_lshr_b32 s56, s50, 1
    s_lshl_b32 s56, s56, 12
    s_add_u32 s55, s55, s56
    s_add_u32 s55, s55, 114688
    v_add_u32 v6, s55, v6
    ds_read_b64_tr_b16 v[96:97], v6 offset:0
    ds_read_b64_tr_b16 v[98:99], v6 offset:512
    ds_read_b64_tr_b16 v[100:101], v6 offset:2048
    ds_read_b64_tr_b16 v[102:103], v6 offset:2560
    v_lshlrev_b32 v7, 4, v1
    s_lshl_b32 s55, s49, 2
    s_add_u32 s55, s55, s50
    s_lshl_b32 s56, s55, 15
    s_lshl_b32 s57, s48, 12
    s_add_u32 s56, s56, s57
    s_add_u32 s56, s56, 4259840
    s_waitcnt lgkmcnt(4)
    buffer_store_dwordx4 v[80:83], v7, s[40:43], s56 offen offset:0 sc1
    buffer_store_dwordx4 v[84:87], v7, s[40:43], s56 offen offset:1024 sc1
    buffer_store_dwordx4 v[88:91], v7, s[40:43], s56 offen offset:2048 sc1
    buffer_store_dwordx4 v[92:95], v7, s[40:43], s56 offen offset:3072 sc1
    v_mov_b32 v8, 0
    v_dot2_f32_bf16 v8, v80, v10, v8
    v_dot2_f32_bf16 v8, v81, v10, v8
    v_dot2_f32_bf16 v8, v82, v10, v8
    v_dot2_f32_bf16 v8, v83, v10, v8
    v_dot2_f32_bf16 v8, v84, v10, v8
    v_dot2_f32_bf16 v8, v85, v10, v8
    v_dot2_f32_bf16 v8, v86, v10, v8
    v_dot2_f32_bf16 v8, v87, v10, v8
    v_dot2_f32_bf16 v8, v88, v10, v8
    v_dot2_f32_bf16 v8, v89, v10, v8
    v_dot2_f32_bf16 v8, v90, v10, v8
    v_dot2_f32_bf16 v8, v91, v10, v8
    v_dot2_f32_bf16 v8, v92, v10, v8
    v_dot2_f32_bf16 v8, v93, v10, v8
    v_dot2_f32_bf16 v8, v94, v10, v8
    v_dot2_f32_bf16 v8, v95, v10, v8
    s_mul_i32 s57, s48, 28672
    s_lshl_b32 s55, s55, 8
    s_add_u32 s57, s57, s55
    s_add_u32 s57, s57, 9764864
    v_lshlrev_b32 v9, 2, v1
    buffer_store_dword v8, v9, s[40:43], s57 offen sc1
    s_lshl_b32 s55, s48, 1
    s_and_b32 s56, s50, 1
    s_add_u32 s55, s55, s56
    s_mul_i32 s55, s55, 114688
    s_lshl_b32 s56, s49, 12
    s_add_u32 s55, s55, s56
    s_lshr_b32 s56, s50, 1
    s_lshl_b32 s56, s56, 11
    s_add_u32 s55, s55, s56
    s_add_u32 s55, s55, 7929856
    s_waitcnt lgkmcnt(0)
    buffer_store_dwordx4 v[96:99], v7, s[40:43], s55 offen offset:0 sc1
    buffer_store_dwordx4 v[100:103], v7, s[40:43], s55 offen offset:1024 sc1
L_rp_16:
    s_cmp_ge_u32 s2, 224
    s_cbranch_scc1 L_w_17
    s_waitcnt vmcnt(8)
    s_branch L_w_18
L_w_17:
    s_waitcnt vmcnt(1)
L_w_18:
    ds_write_b128 v228, v[112:115]
    ds_write_b128 v228, v[116:119] offset:9072
    v_cmp_le_u32 vcc, 124, v0
    s_nop 0
    s_and_saveexec_b64 s[52:53], vcc
    ds_write_b128 v229, v[112:115]
    ds_write_b128 v229, v[116:119] offset:16384
    s_mov_b64 exec, s[52:53]
    s_waitcnt lgkmcnt(0)
    s_barrier
    s_mul_i32 s16, s63, 114688
    s_xor_b32 s17, s63, 1
    s_mul_i32 s17, s17, 114688
    s_mul_i32 s57, s50, 28672
    s_add_u32 s57, s57, 7929856
    s_add_u32 s16, s16, s57
    s_add_u32 s17, s17, s57
    s_and_b32 s52, s50, 1
    s_cmp_lg_u32 s52, 0
    s_cbranch_scc1 L_kh1_19
    ds_read_b128 v[80:83], v224 offset:0
    ds_read_b128 v[112:115], v225 offset:64
    ds_read_b128 v[136:139], v225 offset:0
    ds_read_b128 v[84:87], v224 offset:32
    ds_read_b128 v[116:119], v225 offset:96
    ds_read_b128 v[140:143], v225 offset:32
    ds_read_b128 v[88:91], v224 offset:64
    ds_read_b128 v[120:123], v225 offset:128
    ds_read_b128 v[92:95], v224 offset:96
    ds_read_b128 v[124:127], v225 offset:160
    s_waitcnt lgkmcnt(8)
    v_mfma_f32_32x32x16_bf16 v[16:31], v[80:83], v[112:115], v[16:31]
    ds_read_b128 v[96:99], v224 offset:144
    ds_read_b128 v[128:131], v225 offset:192
    s_waitcnt lgkmcnt(9)
    v_mfma_f32_32x32x16_bf16 v[32:47], v[80:83], v[136:139], v[32:47]
    s_add_u32 s52, s73, 0
    buffer_store_dwordx4 v[48:51], v54, s[40:43], s52 offen sc1
    s_waitcnt lgkmcnt(7)
    v_mfma_f32_32x32x16_bf16 v[16:31], v[84:87], v[116:119], v[16:31]
    ds_read_b128 v[100:103], v224 offset:176
    ds_read_b128 v[132:135], v225 offset:224
    s_waitcnt lgkmcnt(8)
    v_mfma_f32_32x32x16_bf16 v[32:47], v[84:87], v[140:143], v[32:47]
    s_add_u32 s52, s73, 4096
    buffer_store_dwordx4 v[48:51], v54, s[40:43], s52 offen sc1
    s_waitcnt lgkmcnt(6)
    v_mfma_f32_32x32x16_bf16 v[16:31], v[88:91], v[120:123], v[16:31]
    ds_read_b128 v[104:107], v224 offset:208
    ds_read_b128 v[136:139], v225 offset:256
    s_waitcnt lgkmcnt(9)
    v_mfma_f32_32x32x16_bf16 v[32:47], v[88:91], v[112:115], v[32:47]
    s_add_u32 s52, s74, 11075584
    buffer_store_dwordx4 v[48:51], v55, s[40:43], s52 offen sc1
    s_waitcnt lgkmcnt(6)
    v_mfma_f32_32x32x16_bf16 v[16:31], v[92:95], v[124:127], v[16:31]
    ds_read_b128 v[108:111], v224 offset:240
    ds_read_b128 v[140:143], v225 offset:288
    s_waitcnt lgkmcnt(9)
    v_mfma_f32_32x32x16_bf16 v[32:47], v[92:95], v[116:119], v[32:47]
    s_add_u32 s52, s74, 11076608
    buffer_store_dwordx4 v[48:51], v55, s[40:43], s52 offen sc1
    s_waitcnt lgkmcnt(6)
    v_mfma_f32_32x32x16_bf16 v[16:31], v[96:99], v[128:131], v[16:31]
    ds_read_b128 v[80:83], v224 offset:288
    ds_read_b128 v[112:115], v225 offset:320
    s_waitcnt lgkmcnt(9)
    v_mfma_f32_32x32x16_bf16 v[32:47], v[96:99], v[120:123], v[32:47]
    s_add_u32 s52, s74, 13172736
    buffer_store_dwordx4 v[48:51], v55, s[40:43], s52 offen sc1
    s_waitcnt lgkmcnt(6)
    v_mfma_f32_32x32x16_bf16 v[16:31], v[100:103], v[132:135], v[16:31]
    ds_read_b128 v[84:87], v224 offset:320
    ds_read_b128 v[116:119], v225 offset:352
    s_waitcnt lgkmcnt(9)
    v_mfma_f32_32x32x16_bf16 v[32:47], v[100:103], v[124:127], v[32:47]
    s_add_u32 s52, s74, 13173760
    buffer_store_dwordx4 v[48:51], v55, s[40:43], s52 offen sc1
    s_waitcnt lgkmcnt(6)
    v_mfma_f32_32x32x16_bf16 v[16:31], v[104:107], v[136:139], v[16:31]
    ds_read_b128 v[88:91], v224 offset:352
    ds_read_b128 v[120:123], v225 offset:384
    s_waitcnt lgkmcnt(9)
    v_mfma_f32_32x32x16_bf16 v[32:47], v[104:107], v[128:131], v[32:47]
    s_add_u32 s52, s76, 10289152
    s_mov_b64 exec, 0xffffffff
    buffer_store_dwordx2 v[52:53], v56, s[40:43], s52 offen sc1
    s_mov_b64 exec, -1
    s_waitcnt lgkmcnt(6)
    v_mfma_f32_32x32x16_bf16 v[16:31], v[108:111], v[140:143], v[16:31]
    ds_read_b128 v[92:95], v224 offset:384
    ds_read_b128 v[124:127], v225 offset:416
    s_waitcnt lgkmcnt(9)
    v_mfma_f32_32x32x16_bf16 v[32:47], v[108:111], v[132:135], v[32:47]
    s_add_u32 s52, s76, 10551296
    s_mov_b64 exec, 0xffffffff
    buffer_store_dwordx2 v[52:53], v56, s[40:43], s52 offen sc1
    s_mov_b64 exec, -1
    s_waitcnt lgkmcnt(6)
    v_mfma_f32_32x32x16_bf16 v[16:31], v[80:83], v[112:115], v[16:31]
    ds_read_b128 v[96:99], v224 offset:432
    ds_read_b128 v[128:131], v225 offset:448
    s_waitcnt lgkmcnt(9)
    v_mfma_f32_32x32x16_bf16 v[32:47], v[80:83], v[136:139], v[32:47]
    s_add_u32 s52, s76, 10813440
    s_mov_b64 exec, 0xffffffff
    buffer_store_dwordx2 v[52:53], v56, s[40:43], s52 offen sc1
    s_mov_b64 exec, -1
    s_waitcnt lgkmcnt(6)
    v_mfma_f32_32x32x16_bf16 v[16:31], v[84:87], v[116:119], v[16:31]
    ds_read_b128 v[100:103], v224 offset:464
    ds_read_b128 v[132:135], v225 offset:480
    s_waitcnt lgkmcnt(9)
    v_mfma_f32_32x32x16_bf16 v[32:47], v[84:87], v[140:143], v[32:47]
    s_lshl_b32 s52, s2, 10
    s_add_u32 s52, s52, 30670848
    v_lshlrev_b32 v57, 7, v1
    s_mov_b64 exec, 0xff
    buffer_store_dword v52, v57, s[40:43], s52 offen sc1
    s_mov_b64 exec, -1
    s_waitcnt lgkmcnt(6)
    v_mfma_f32_32x32x16_bf16 v[16:31], v[88:91], v[120:123], v[16:31]
    ds_read_b128 v[104:107], v224 offset:496
    ds_read_b128 v[136:139], v225 offset:512
    s_waitcnt lgkmcnt(9)
    v_mfma_f32_32x32x16_bf16 v[32:47], v[88:91], v[112:115], v[32:47]
    s_waitcnt lgkmcnt(6)
    v_mfma_f32_32x32x16_bf16 v[16:31], v[92:95], v[124:127], v[16:31]
    ds_read_b128 v[108:111], v224 offset:528
    ds_read_b128 v[140:143], v225 offset:544
    s_waitcnt lgkmcnt(9)
    v_mfma_f32_32x32x16_bf16 v[32:47], v[92:95], v[116:119], v[32:47]
    s_waitcnt lgkmcnt(6)
    v_mfma_f32_32x32x16_bf16 v[16:31], v[96:99], v[128:131], v[16:31]
    ds_read_b128 v[80:83], v224 offset:576
    ds_read_b128 v[112:115], v225 offset:576
    s_waitcnt lgkmcnt(9)
    v_mfma_f32_32x32x16_bf16 v[32:47], v[96:99], v[120:123], v[32:47]
    s_waitcnt lgkmcnt(6)
    v_mfma_f32_32x32x16_bf16 v[16:31], v[100:103], v[132:135], v[16:31]
    ds_read_b128 v[84:87], v224 offset:608
    ds_read_b128 v[116:119], v225 offset:608
    s_waitcnt lgkmcnt(9)
    v_mfma_f32_32x32x16_bf16 v[32:47], v[100:103], v[124:127], v[32:47]
    s_waitcnt lgkmcnt(6)
    v_mfma_f32_32x32x16_bf16 v[16:31], v[104:107], v[136:139], v[16:31]
    ds_read_b128 v[88:91], v224 offset:640
    ds_read_b128 v[120:123], v225 offset:640
    s_waitcnt lgkmcnt(9)
    v_mfma_f32_32x32x16_bf16 v[32:47], v[104:107], v[128:131], v[32:47]
    s_waitcnt lgkmcnt(6)
    v_mfma_f32_32x32x16_bf16 v[16:31], v[108:111], v[140:143], v[16:31]
    ds_read_b128 v[92:95], v224 offset:672
    ds_read_b128 v[124:127], v225 offset:672
    s_waitcnt lgkmcnt(9)
    v_mfma_f32_32x32x16_bf16 v[32:47], v[108:111], v[132:135], v[32:47]
    s_waitcnt lgkmcnt(6)
    v_mfma_f32_32x32x16_bf16 v[16:31], v[80:83], v[112:115], v[16:31]
    ds_read_b128 v[96:99], v224 offset:720
    ds_read_b128 v[128:131], v225 offset:704
    s_waitcnt lgkmcnt(9)
    v_mfma_f32_32x32x16_bf16 v[32:47], v[80:83], v[136:139], v[32:47]
    s_waitcnt lgkmcnt(6)
    v_mfma_f32_32x32x16_bf16 v[16:31], v[84:87], v[116:119], v[16:31]
    ds_read_b128 v[100:103], v224 offset:752
    ds_read_b128 v[132:135], v225 offset:736
    s_waitcnt lgkmcnt(9)
    v_mfma_f32_32x32x16_bf16 v[32:47], v[84:87], v[140:143], v[32:47]
    s_waitcnt lgkmcnt(6)
    v_mfma_f32_32x32x16_bf16 v[16:31], v[88:91], v[120:123], v[16:31]
    ds_read_b128 v[104:107], v224 offset:784
    ds_read_b128 v[136:139], v225 offset:768
    s_waitcnt lgkmcnt(9)
    v_mfma_f32_32x32x16_bf16 v[32:47], v[88:91], v[112:115], v[32:47]
    s_waitcnt lgkmcnt(6)
    v_mfma_f32_32x32x16_bf16 v[16:31], v[92:95], v[124:127], v[16:31]
    ds_read_b128 v[108:111], v224 offset:816
    ds_read_b128 v[140:143], v225 offset:800
    s_waitcnt lgkmcnt(9)
    v_mfma_f32_32x32x16_bf16 v[32:47], v[92:95], v[116:119], v[32:47]
    s_waitcnt lgkmcnt(6)
    v_mfma_f32_32x32x16_bf16 v[16:31], v[96:99], v[128:131], v[16:31]
    ds_read_b128 v[80:83], v224 offset:864
    ds_read_b128 v[112:115], v225 offset:832
    s_waitcnt lgkmcnt(9)
    v_mfma_f32_32x32x16_bf16 v[32:47], v[96:99], v[120:123], v[32:47]
    s_waitcnt lgkmcnt(6)
    v_mfma_f32_32x32x16_bf16 v[16:31], v[100:103], v[132:135], v[16:31]
    ds_read_b128 v[84:87], v224 offset:896
    ds_read_b128 v[116:119], v225 offset:864
    s_waitcnt lgkmcnt(9)
    v_mfma_f32_32x32x16_bf16 v[32:47], v[100:103], v[124:127], v[32:47]
    s_waitcnt lgkmcnt(6)
    v_mfma_f32_32x32x16_bf16 v[16:31], v[104:107], v[136:139], v[16:31]
    ds_read_b128 v[88:91], v224 offset:928
    ds_read_b128 v[120:123], v225 offset:896
    s_waitcnt lgkmcnt(9)
    v_mfma_f32_32x32x16_bf16 v[32:47], v[104:107], v[128:131], v[32:47]
    s_waitcnt lgkmcnt(6)
    v_mfma_f32_32x32x16_bf16 v[16:31], v[108:111], v[140:143], v[16:31]
    ds_read_b128 v[92:95], v224 offset:960
    ds_read_b128 v[124:127], v225 offset:928
    s_waitcnt lgkmcnt(9)
    v_mfma_f32_32x32x16_bf16 v[32:47], v[108:111], v[132:135], v[32:47]
    s_waitcnt lgkmcnt(6)
    v_mfma_f32_32x32x16_bf16 v[16:31], v[80:83], v[112:115], v[16:31]
    ds_read_b128 v[96:99], v224 offset:1008
    ds_read_b128 v[128:131], v225 offset:960
    s_waitcnt lgkmcnt(9)
    v_mfma_f32_32x32x16_bf16 v[32:47], v[80:83], v[136:139], v[32:47]
    s_waitcnt lgkmcnt(6)
    v_mfma_f32_32x32x16_bf16 v[16:31], v[84:87], v[116:119], v[16:31]
    ds_read_b128 v[100:103], v224 offset:1040
    ds_read_b128 v[132:135], v225 offset:992
    s_waitcnt lgkmcnt(9)
    v_mfma_f32_32x32x16_bf16 v[32:47], v[84:87], v[140:143], v[32:47]
    s_waitcnt lgkmcnt(6)
    v_mfma_f32_32x32x16_bf16 v[16:31], v[88:91], v[120:123], v[16:31]
    ds_read_b128 v[104:107], v224 offset:1072
    ds_read_b128 v[136:139], v225 offset:1024
    s_waitcnt lgkmcnt(9)
    v_mfma_f32_32x32x16_bf16 v[32:47], v[88:91], v[112:115], v[32:47]
    s_waitcnt lgkmcnt(6)
    v_mfma_f32_32x32x16_bf16 v[16:31], v[92:95], v[124:127], v[16:31]
    ds_read_b128 v[108:111], v224 offset:1104
    ds_read_b128 v[140:143], v225 offset:1056
    s_waitcnt lgkmcnt(9)
    v_mfma_f32_32x32x16_bf16 v[32:47], v[92:95], v[116:119], v[32:47]
    s_waitcnt lgkmcnt(6)
    v_mfma_f32_32x32x16_bf16 v[16:31], v[96:99], v[128:131], v[16:31]
    ds_read_b128 v[80:83], v224 offset:1152
    ds_read_b128 v[112:115], v225 offset:1088
    s_waitcnt lgkmcnt(9)
    v_mfma_f32_32x32x16_bf16 v[32:47], v[96:99], v[120:123], v[32:47]
    s_waitcnt lgkmcnt(6)
    v_mfma_f32_32x32x16_bf16 v[16:31], v[100:103], v[132:135], v[16:31]
    ds_read_b128 v[84:87], v224 offset:1184
    ds_read_b128 v[116:119], v225 offset:1120
    s_waitcnt lgkmcnt(9)
    v_mfma_f32_32x32x16_bf16 v[32:47], v[100:103], v[124:127], v[32:47]
    s_waitcnt vmcnt(0)
    s_barrier
    s_cmp_lg_u32 s50, 0
    s_cbranch_scc1 L_ar_21
    s_mov_b64 exec, 0xff
    s_add_u32 s52, s48, 128
    v_lshlrev_b32 v2, 3, v1
    v_add_u32 v2, s52, v2
    v_lshlrev_b32 v2, 8, v2
    v_mov_b32 v3, 1
    buffer_atomic_add v3, v2, s[40:43], 0 offen sc1
    s_mov_b64 exec, -1
L_ar_21:
    s_waitcnt lgkmcnt(6)
    v_mfma_f32_32x32x16_bf16 v[16:31], v[104:107], v[136:139], v[16:31]
    ds_read_b128 v[88:91], v224 offset:1216
    ds_read_b128 v[120:123], v225 offset:1152
    s_waitcnt lgkmcnt(9)
    v_mfma_f32_32x32x16_bf16 v[32:47], v[104:107], v[128:131], v[32:47]
    s_waitcnt lgkmcnt(6)
    v_mfma_f32_32x32x16_bf16 v[16:31], v[108:111], v[140:143], v[16:31]
    ds_read_b128 v[92:95], v224 offset:1248
    ds_read_b128 v[124:127], v225 offset:1184
    s_waitcnt lgkmcnt(9)
    v_mfma_f32_32x32x16_bf16 v[32:47], v[108:111], v[132:135], v[32:47]
    s_waitcnt lgkmcnt(6)
    v_mfma_f32_32x32x16_bf16 v[16:31], v[80:83], v[112:115], v[16:31]
    ds_read_b128 v[96:99], v224 offset:1296
    ds_read_b128 v[128:131], v225 offset:1216
    s_waitcnt lgkmcnt(9)
    v_mfma_f32_32x32x16_bf16 v[32:47], v[80:83], v[136:139], v[32:47]
    s_waitcnt lgkmcnt(6)
    v_mfma_f32_32x32x16_bf16 v[16:31], v[84:87], v[116:119], v[16:31]
    ds_read_b128 v[100:103], v224 offset:1328
    ds_read_b128 v[132:135], v225 offset:1248
    s_waitcnt lgkmcnt(9)
    v_mfma_f32_32x32x16_bf16 v[32:47], v[84:87], v[140:143], v[32:47]
    s_waitcnt lgkmcnt(6)
    v_mfma_f32_32x32x16_bf16 v[16:31], v[88:91], v[120:123], v[16:31]
    ds_read_b128 v[104:107], v224 offset:1360
    ds_read_b128 v[136:139], v225 offset:1280
    s_waitcnt lgkmcnt(9)
    v_mfma_f32_32x32x16_bf16 v[32:47], v[88:91], v[112:115], v[32:47]
    s_waitcnt lgkmcnt(6)
    v_mfma_f32_32x32x16_bf16 v[16:31], v[92:95], v[124:127], v[16:31]
    ds_read_b128 v[108:111], v224 offset:1392
    ds_read_b128 v[140:143], v225 offset:1312
    s_waitcnt lgkmcnt(9)
    v_mfma_f32_32x32x16_bf16 v[32:47], v[92:95], v[116:119], v[32:47]
    s_waitcnt lgkmcnt(6)
    v_mfma_f32_32x32x16_bf16 v[16:31], v[96:99], v[128:131], v[16:31]
    ds_read_b128 v[80:83], v224 offset:1440
    ds_read_b128 v[112:115], v225 offset:1344
    s_waitcnt lgkmcnt(9)
    v_mfma_f32_32x32x16_bf16 v[32:47], v[96:99], v[120:123], v[32:47]
    s_waitcnt lgkmcnt(6)
    v_mfma_f32_32x32x16_bf16 v[16:31], v[100:103], v[132:135], v[16:31]
    ds_read_b128 v[84:87], v224 offset:1472
    ds_read_b128 v[116:119], v225 offset:1376
    s_waitcnt lgkmcnt(9)
    v_mfma_f32_32x32x16_bf16 v[32:47], v[100:103], v[124:127], v[32:47]
    s_waitcnt lgkmcnt(6)
    v_mfma_f32_32x32x16_bf16 v[16:31], v[104:107], v[136:139], v[16:31]
    ds_read_b128 v[88:91], v224 offset:1504
    ds_read_b128 v[120:123], v225 offset:1408
    s_waitcnt lgkmcnt(9)
    v_mfma_f32_32x32x16_bf16 v[32:47], v[104:107], v[128:131], v[32:47]
    s_waitcnt lgkmcnt(6)
    v_mfma_f32_32x32x16_bf16 v[16:31], v[108:111], v[140:143], v[16:31]
    ds_read_b128 v[92:95], v224 offset:1536
    ds_read_b128 v[124:127], v225 offset:1440
    s_waitcnt lgkmcnt(9)
    v_mfma_f32_32x32x16_bf16 v[32:47], v[108:111], v[132:135], v[32:47]
    s_waitcnt lgkmcnt(6)
    v_mfma_f32_32x32x16_bf16 v[16:31], v[80:83], v[112:115], v[16:31]
    ds_read_b128 v[96:99], v224 offset:1584
    ds_read_b128 v[128:131], v225 offset:1472
    s_waitcnt lgkmcnt(9)
    v_mfma_f32_32x32x16_bf16 v[32:47], v[80:83], v[136:139], v[32:47]
    s_waitcnt lgkmcnt(6)
    v_mfma_f32_32x32x16_bf16 v[16:31], v[84:87], v[116:119], v[16:31]
    ds_read_b128 v[100:103], v224 offset:1616
    ds_read_b128 v[132:135], v225 offset:1504
    s_waitcnt lgkmcnt(9)
    v_mfma_f32_32x32x16_bf16 v[32:47], v[84:87], v[140:143], v[32:47]
    s_waitcnt lgkmcnt(6)
    v_mfma_f32_32x32x16_bf16 v[16:31], v[88:91], v[120:123], v[16:31]
    ds_read_b128 v[104:107], v224 offset:1648
    ds_read_b128 v[136:139], v225 offset:1536
    s_waitcnt lgkmcnt(9)
    v_mfma_f32_32x32x16_bf16 v[32:47], v[88:91], v[112:115], v[32:47]
    s_waitcnt lgkmcnt(6)
    v_mfma_f32_32x32x16_bf16 v[16:31], v[92:95], v[124:127], v[16:31]
    ds_read_b128 v[108:111], v224 offset:1680
    ds_read_b128 v[140:143], v225 offset:1568
    s_waitcnt lgkmcnt(9)
    v_mfma_f32_32x32x16_bf16 v[32:47], v[92:95], v[116:119], v[32:47]
    s_waitcnt lgkmcnt(6)
    v_mfma_f32_32x32x16_bf16 v[16:31], v[96:99], v[128:131], v[16:31]
    s_waitcnt lgkmcnt(7)
    v_mfma_f32_32x32x16_bf16 v[32:47], v[96:99], v[120:123], v[32:47]
    s_waitcnt lgkmcnt(4)
    v_mfma_f32_32x32x16_bf16 v[16:31], v[100:103], v[132:135], v[16:31]
    s_waitcnt lgkmcnt(5)
    v_mfma_f32_32x32x16_bf16 v[32:47], v[100:103], v[124:127], v[32:47]
    s_waitcnt lgkmcnt(2)
    v_mfma_f32_32x32x16_bf16 v[16:31], v[104:107], v[136:139], v[16:31]
    s_waitcnt lgkmcnt(3)
    v_mfma_f32_32x32x16_bf16 v[32:47], v[104:107], v[128:131], v[32:47]
    s_waitcnt lgkmcnt(0)
    v_mfma_f32_32x32x16_bf16 v[16:31], v[108:111], v[140:143], v[16:31]
    s_waitcnt lgkmcnt(1)
    v_mfma_f32_32x32x16_bf16 v[32:47], v[108:111], v[132:135], v[32:47]
    v_and_b32 v2, 31, v1
    v_sub_u32 v2, 63, v2
    v_lshlrev_b32 v2, 2, v2
    v_lshrrev_b32 v3, 5, v1
    v_lshlrev_b32 v3, 10, v3
    v_add_u32 v2, v2, v3
    s_lshl_b32 s55, s50, 13
    s_add_u32 s55, s55, 122752
    v_add_u32 v2, s55, v2
    s_waitcnt lgkmcnt(0)
    s_nop 7
    s_nop 1
    ds_write_b32 v2, v16 offset:128
    ds_write_b32 v2, v17 offset:384
    ds_write_b32 v2, v18 offset:640
    ds_write_b32 v2, v19 offset:896
    ds_write_b32 v2, v20 offset:2176
    ds_write_b32 v2, v21 offset:2432
    ds_write_b32 v2, v22 offset:2688
    ds_write_b32 v2, v23 offset:2944
    ds_write_b32 v2, v24 offset:4224
    ds_write_b32 v2, v25 offset:4480
    ds_write_b32 v2, v26 offset:4736
    ds_write_b32 v2, v27 offset:4992
    ds_write_b32 v2, v28 offset:6272
    ds_write_b32 v2, v29 offset:6528
    ds_write_b32 v2, v30 offset:6784
    ds_write_b32 v2, v31 offset:7040
    ds_write_b32 v2, v32 offset:0
    ds_write_b32 v2, v33 offset:256
    ds_write_b32 v2, v34 offset:512
    ds_write_b32 v2, v35 offset:768
    ds_write_b32 v2, v36 offset:2048
    ds_write_b32 v2, v37 offset:2304
    ds_write_b32 v2, v38 offset:2560
    ds_write_b32 v2, v39 offset:2816
    ds_write_b32 v2, v40 offset:4096
    ds_write_b32 v2, v41 offset:4352
    ds_write_b32 v2, v42 offset:4608
    ds_write_b32 v2, v43 offset:4864
    ds_write_b32 v2, v44 offset:6144
    ds_write_b32 v2, v45 offset:6400
    ds_write_b32 v2, v46 offset:6656
    ds_write_b32 v2, v47 offset:6912
    s_branch L_khj_20
L_kh1_19:
    ds_read_b128 v[80:83], v224 offset:0
    ds_read_b128 v[112:115], v225 offset:64
    ds_read_b128 v[136:139], v225 offset:0
    ds_read_b128 v[84:87], v224 offset:32
    ds_read_b128 v[116:119], v225 offset:96
    ds_read_b128 v[140:143], v225 offset:32
    ds_read_b128 v[88:91], v224 offset:64
    ds_read_b128 v[120:123], v225 offset:128
    ds_read_b128 v[92:95], v224 offset:96
    ds_read_b128 v[124:127], v225 offset:160
    s_waitcnt lgkmcnt(8)
    v_mfma_f32_32x32x16_bf16 v[16:31], v[80:83], v[112:115], v[16:31]
    ds_read_b128 v[96:99], v224 offset:144
    ds_read_b128 v[128:131], v225 offset:192
    s_waitcnt lgkmcnt(9)
    v_mfma_f32_32x32x16_bf16 v[32:47], v[80:83], v[136:139], v[32:47]
    s_add_u32 s52, s73, 0
    buffer_store_dwordx4 v[48:51], v54, s[40:43], s52 offen sc1
    s_waitcnt lgkmcnt(7)
    v_mfma_f32_32x32x16_bf16 v[16:31], v[84:87], v[116:119], v[16:31]
    ds_read_b128 v[100:103], v224 offset:176
    ds_read_b128 v[132:135], v225 offset:224
    s_waitcnt lgkmcnt(8)
    v_mfma_f32_32x32x16_bf16 v[32:47], v[84:87], v[140:143], v[32:47]
    s_add_u32 s52, s73, 4096
    buffer_store_dwordx4 v[48:51], v54, s[40:43], s52 offen sc1
    s_waitcnt lgkmcnt(6)
    v_mfma_f32_32x32x16_bf16 v[16:31], v[88:91], v[120:123], v[16:31]
    ds_read_b128 v[104:107], v224 offset:208
    ds_read_b128 v[136:139], v225 offset:256
    s_waitcnt lgkmcnt(9)
    v_mfma_f32_32x32x16_bf16 v[32:47], v[88:91], v[112:115], v[32:47]
    s_add_u32 s52, s74, 11075584
    buffer_store_dwordx4 v[48:51], v55, s[40:43], s52 offen sc1
    s_waitcnt lgkmcnt(6)
    v_mfma_f32_32x32x16_bf16 v[16:31], v[92:95], v[124:127], v[16:31]
    ds_read_b128 v[108:111], v224 offset:240
    ds_read_b128 v[140:143], v225 offset:288
    s_waitcnt lgkmcnt(9)
    v_mfma_f32_32x32x16_bf16 v[32:47], v[92:95], v[116:119], v[32:47]
    s_add_u32 s52, s74, 11076608
    buffer_store_dwordx4 v[48:51], v55, s[40:43], s52 offen sc1
    s_waitcnt lgkmcnt(6)
    v_mfma_f32_32x32x16_bf16 v[16:31], v[96:99], v[128:131], v[16:31]
    ds_read_b128 v[80:83], v224 offset:288
    ds_read_b128 v[112:115], v225 offset:320
    s_waitcnt lgkmcnt(9)
    v_mfma_f32_32x32x16_bf16 v[32:47], v[96:99], v[120:123], v[32:47]
    s_add_u32 s52, s74, 13172736
    buffer_store_dwordx4 v[48:51], v55, s[40:43], s52 offen sc1
    s_waitcnt lgkmcnt(6)
    v_mfma_f32_32x32x16_bf16 v[16:31], v[100:103], v[132:135], v[16:31]
    ds_read_b128 v[84:87], v224 offset:320
    ds_read_b128 v[116:119], v225 offset:352
    s_waitcnt lgkmcnt(9)
    v_mfma_f32_32x32x16_bf16 v[32:47], v[100:103], v[124:127], v[32:47]
    s_add_u32 s52, s74, 13173760
    buffer_store_dwordx4 v[48:51], v55, s[40:43], s52 offen sc1
    s_waitcnt lgkmcnt(6)
    v_mfma_f32_32x32x16_bf16 v[16:31], v[104:107], v[136:139], v[16:31]
    ds_read_b128 v[88:91], v224 offset:352
    ds_read_b128 v[120:123], v225 offset:384
    s_waitcnt lgkmcnt(9)
    v_mfma_f32_32x32x16_bf16 v[32:47], v[104:107], v[128:131], v[32:47]
    s_add_u32 s52, s76, 10289152
    s_mov_b64 exec, 0xffffffff
    buffer_store_dwordx2 v[52:53], v56, s[40:43], s52 offen sc1
    s_mov_b64 exec, -1
    s_waitcnt lgkmcnt(6)
    v_mfma_f32_32x32x16_bf16 v[16:31], v[108:111], v[140:143], v[16:31]
    ds_read_b128 v[92:95], v224 offset:384
    ds_read_b128 v[124:127], v225 offset:416
    s_waitcnt lgkmcnt(9)
    v_mfma_f32_32x32x16_bf16 v[32:47], v[108:111], v[132:135], v[32:47]
    s_add_u32 s52, s76, 10551296
    s_mov_b64 exec, 0xffffffff
    buffer_store_dwordx2 v[52:53], v56, s[40:43], s52 offen sc1
    s_mov_b64 exec, -1
    s_waitcnt lgkmcnt(6)
    v_mfma_f32_32x32x16_bf16 v[16:31], v[80:83], v[112:115], v[16:31]
    ds_read_b128 v[96:99], v224 offset:432
    ds_read_b128 v[128:131], v225 offset:448
    s_waitcnt lgkmcnt(9)
    v_mfma_f32_32x32x16_bf16 v[32:47], v[80:83], v[136:139], v[32:47]
    s_add_u32 s52, s76, 10813440
    s_mov_b64 exec, 0xffffffff
    buffer_store_dwordx2 v[52:53], v56, s[40:43], s52 offen sc1
    s_mov_b64 exec, -1
    s_waitcnt lgkmcnt(6)
    v_mfma_f32_32x32x16_bf16 v[16:31], v[84:87], v[116:119], v[16:31]
    ds_read_b128 v[100:103], v224 offset:464
    ds_read_b128 v[132:135], v225 offset:480
    s_waitcnt lgkmcnt(9)
    v_mfma_f32_32x32x16_bf16 v[32:47], v[84:87], v[140:143], v[32:47]
    s_lshl_b32 s52, s2, 10
    s_add_u32 s52, s52, 30670848
    v_lshlrev_b32 v57, 7, v1
    s_mov_b64 exec, 0xff
    buffer_store_dword v52, v57, s[40:43], s52 offen sc1
    s_mov_b64 exec, -1
    s_waitcnt lgkmcnt(6)
    v_mfma_f32_32x32x16_bf16 v[16:31], v[88:91], v[120:123], v[16:31]
    ds_read_b128 v[104:107], v224 offset:496
    ds_read_b128 v[136:139], v225 offset:512
    s_waitcnt lgkmcnt(9)
    v_mfma_f32_32x32x16_bf16 v[32:47], v[88:91], v[112:115], v[32:47]
    s_waitcnt lgkmcnt(6)
    v_mfma_f32_32x32x16_bf16 v[16:31], v[92:95], v[124:127], v[16:31]
    ds_read_b128 v[108:111], v224 offset:528
    ds_read_b128 v[140:143], v225 offset:544
    s_waitcnt lgkmcnt(9)
    v_mfma_f32_32x32x16_bf16 v[32:47], v[92:95], v[116:119], v[32:47]
    s_waitcnt lgkmcnt(6)
    v_mfma_f32_32x32x16_bf16 v[16:31], v[96:99], v[128:131], v[16:31]
    ds_read_b128 v[160:163], v227 offset:0
    ds_read_b128 v[192:195], v225 offset:512
    s_waitcnt lgkmcnt(9)
    v_mfma_f32_32x32x16_bf16 v[32:47], v[96:99], v[120:123], v[32:47]
    ds_read_b128 v[164:167], v227 offset:32
    ds_read_b128 v[196:199], v225 offset:544
    s_waitcnt lgkmcnt(8)
    v_mfma_f32_32x32x16_bf16 v[16:31], v[100:103], v[132:135], v[16:31]
    ds_read_b128 v[168:171], v226 offset:80
    ds_read_b128 v[200:203], v225 offset:576
    s_waitcnt lgkmcnt(11)
    v_mfma_f32_32x32x16_bf16 v[32:47], v[100:103], v[124:127], v[32:47]
    ds_read_b128 v[172:175], v226 offset:112
    ds_read_b128 v[204:207], v225 offset:608
    s_waitcnt lgkmcnt(10)
    v_mfma_f32_32x32x16_bf16 v[16:31], v[104:107], v[136:139], v[16:31]
    ds_read_b128 v[176:179], v226 offset:160
    ds_read_b128 v[208:211], v225 offset:640
    s_waitcnt lgkmcnt(13)
    v_mfma_f32_32x32x16_bf16 v[32:47], v[104:107], v[128:131], v[32:47]
    ds_read_b128 v[180:183], v226 offset:192
    ds_read_b128 v[212:215], v225 offset:672
    s_waitcnt lgkmcnt(12)
    v_mfma_f32_32x32x16_bf16 v[16:31], v[108:111], v[140:143], v[16:31]
    ds_read_b128 v[184:187], v226 offset:240
    ds_read_b128 v[216:219], v225 offset:704
    s_waitcnt lgkmcnt(15)
    v_mfma_f32_32x32x16_bf16 v[32:47], v[108:111], v[132:135], v[32:47]
    ds_read_b128 v[188:191], v226 offset:272
    ds_read_b128 v[220:223], v225 offset:736
    s_waitcnt lgkmcnt(14)
    v_mfma_f32_32x32x16_bf16 v[144:159], v[160:163], v[192:195], v[144:159]
    ds_read_b128 v[160:163], v226 offset:320
    ds_read_b128 v[192:195], v225 offset:768
    s_waitcnt lgkmcnt(14)
    v_mfma_f32_32x32x16_bf16 v[144:159], v[164:167], v[196:199], v[144:159]
    ds_read_b128 v[164:167], v226 offset:352
    ds_read_b128 v[196:199], v225 offset:800
    s_waitcnt lgkmcnt(14)
    v_mfma_f32_32x32x16_bf16 v[144:159], v[168:171], v[200:203], v[144:159]
    ds_read_b128 v[168:171], v226 offset:400
    ds_read_b128 v[200:203], v225 offset:832
    s_waitcnt lgkmcnt(14)
    v_mfma_f32_32x32x16_bf16 v[144:159], v[172:175], v[204:207], v[144:159]
    ds_read_b128 v[172:175], v226 offset:432
    ds_read_b128 v[204:207], v225 offset:864
    s_waitcnt lgkmcnt(14)
    v_mfma_f32_32x32x16_bf16 v[144:159], v[176:179], v[208:211], v[144:159]
    ds_read_b128 v[176:179], v226 offset:480
    ds_read_b128 v[208:211], v225 offset:896
    s_waitcnt lgkmcnt(14)
    v_mfma_f32_32x32x16_bf16 v[144:159], v[180:183], v[212:215], v[144:159]
    ds_read_b128 v[180:183], v226 offset:512
    ds_read_b128 v[212:215], v225 offset:928
    s_waitcnt lgkmcnt(14)
    v_mfma_f32_32x32x16_bf16 v[144:159], v[184:187], v[216:219], v[144:159]
    ds_read_b128 v[184:187], v226 offset:560
    ds_read_b128 v[216:219], v225 offset:960
    s_waitcnt lgkmcnt(14)
    v_mfma_f32_32x32x16_bf16 v[144:159], v[188:191], v[220:223], v[144:159]
    ds_read_b128 v[188:191], v226 offset:592
    ds_read_b128 v[220:223], v225 offset:992
    s_waitcnt lgkmcnt(14)
    v_mfma_f32_32x32x16_bf16 v[144:159], v[160:163], v[192:195], v[144:159]
    ds_read_b128 v[160:163], v226 offset:640
    ds_read_b128 v[192:195], v225 offset:1024
    s_waitcnt lgkmcnt(14)
    v_mfma_f32_32x32x16_bf16 v[144:159], v[164:167], v[196:199], v[144:159]
    ds_read_b128 v[164:167], v226 offset:672
    ds_read_b128 v[196:199], v225 offset:1056
    s_waitcnt lgkmcnt(14)
    v_mfma_f32_32x32x16_bf16 v[144:159], v[168:171], v[200:203], v[144:159]
    ds_read_b128 v[168:171], v226 offset:720
    ds_read_b128 v[200:203], v225 offset:1088
    s_waitcnt lgkmcnt(14)
    v_mfma_f32_32x32x16_bf16 v[144:159], v[172:175], v[204:207], v[144:159]
    ds_read_b128 v[172:175], v226 offset:752
    ds_read_b128 v[204:207], v225 offset:1120
    s_waitcnt lgkmcnt(14)
    v_mfma_f32_32x32x16_bf16 v[144:159], v[176:179], v[208:211], v[144:159]
    ds_read_b128 v[176:179], v226 offset:800
    ds_read_b128 v[208:211], v225 offset:1152
    s_waitcnt lgkmcnt(14)
    v_mfma_f32_32x32x16_bf16 v[144:159], v[180:183], v[212:215], v[144:159]
    ds_read_b128 v[180:183], v226 offset:832
    ds_read_b128 v[212:215], v225 offset:1184
    s_waitcnt lgkmcnt(14)
    v_mfma_f32_32x32x16_bf16 v[144:159], v[184:187], v[216:219], v[144:159]
    ds_read_b128 v[184:187], v226 offset:880
    ds_read_b128 v[216:219], v225 offset:1216
    s_waitcnt lgkmcnt(14)
    v_mfma_f32_32x32x16_bf16 v[144:159], v[188:191], v[220:223], v[144:159]
    ds_read_b128 v[188:191], v226 offset:912
    ds_read_b128 v[220:223], v225 offset:1248
    s_waitcnt lgkmcnt(14)
    v_mfma_f32_32x32x16_bf16 v[144:159], v[160:163], v[192:195], v[144:159]
    ds_read_b128 v[160:163], v226 offset:960
    ds_read_b128 v[192:195], v225 offset:1280
    s_waitcnt lgkmcnt(14)
    v_mfma_f32_32x32x16_bf16 v[144:159], v[164:167], v[196:199], v[144:159]
    ds_read_b128 v[164:167], v226 offset:992
    ds_read_b128 v[196:199], v225 offset:1312
    s_waitcnt lgkmcnt(14)
    v_mfma_f32_32x32x16_bf16 v[144:159], v[168:171], v[200:203], v[144:159]
    ds_read_b128 v[168:171], v226 offset:1040
    ds_read_b128 v[200:203], v225 offset:1344
    s_waitcnt lgkmcnt(14)
    v_mfma_f32_32x32x16_bf16 v[144:159], v[172:175], v[204:207], v[144:159]
    ds_read_b128 v[172:175], v226 offset:1072
    ds_read_b128 v[204:207], v225 offset:1376
    s_waitcnt lgkmcnt(14)
    v_mfma_f32_32x32x16_bf16 v[144:159], v[176:179], v[208:211], v[144:159]
    ds_read_b128 v[176:179], v226 offset:1120
    ds_read_b128 v[208:211], v225 offset:1408
    s_waitcnt lgkmcnt(14)
    v_mfma_f32_32x32x16_bf16 v[144:159], v[180:183], v[212:215], v[144:159]
    ds_read_b128 v[180:183], v226 offset:1152
    ds_read_b128 v[212:215], v225 offset:1440
    s_waitcnt lgkmcnt(14)
    v_mfma_f32_32x32x16_bf16 v[144:159], v[184:187], v[216:219], v[144:159]
    ds_read_b128 v[184:187], v226 offset:1200
    ds_read_b128 v[216:219], v225 offset:1472
    s_waitcnt lgkmcnt(14)
    v_mfma_f32_32x32x16_bf16 v[144:159], v[188:191], v[220:223], v[144:159]
    ds_read_b128 v[188:191], v226 offset:1232
    ds_read_b128 v[220:223], v225 offset:1504
    s_waitcnt lgkmcnt(14)
    v_mfma_f32_32x32x16_bf16 v[144:159], v[160:163], v[192:195], v[144:159]
    ds_read_b128 v[160:163], v226 offset:1280
    ds_read_b128 v[192:195], v225 offset:1536
    s_waitcnt lgkmcnt(14)
    v_mfma_f32_32x32x16_bf16 v[144:159], v[164:167], v[196:199], v[144:159]
    ds_read_b128 v[164:167], v226 offset:1312
    ds_read_b128 v[196:199], v225 offset:1568
    s_waitcnt lgkmcnt(14)
    v_mfma_f32_32x32x16_bf16 v[144:159], v[168:171], v[200:203], v[144:159]
    ds_read_b128 v[168:171], v226 offset:1360
    ds_read_b128 v[200:203], v225 offset:1600
    s_waitcnt lgkmcnt(14)
    v_mfma_f32_32x32x16_bf16 v[144:159], v[172:175], v[204:207], v[144:159]
    ds_read_b128 v[172:175], v226 offset:1392
    ds_read_b128 v[204:207], v225 offset:1632
    s_waitcnt vmcnt(0)
    s_barrier
    s_waitcnt lgkmcnt(14)
    v_mfma_f32_32x32x16_bf16 v[144:159], v[176:179], v[208:211], v[144:159]
    ds_read_b128 v[176:179], v226 offset:1440
    ds_read_b128 v[208:211], v225 offset:1664
    s_waitcnt lgkmcnt(14)
    v_mfma_f32_32x32x16_bf16 v[144:159], v[180:183], v[212:215], v[144:159]
    ds_read_b128 v[180:183], v226 offset:1472
    ds_read_b128 v[212:215], v225 offset:1696
    s_waitcnt lgkmcnt(14)
    v_mfma_f32_32x32x16_bf16 v[144:159], v[184:187], v[216:219], v[144:159]
    ds_read_b128 v[184:187], v226 offset:1520
    ds_read_b128 v[216:219], v225 offset:1728
    s_waitcnt lgkmcnt(14)
    v_mfma_f32_32x32x16_bf16 v[144:159], v[188:191], v[220:223], v[144:159]
    ds_read_b128 v[188:191], v226 offset:1552
    ds_read_b128 v[220:223], v225 offset:1760
    s_waitcnt lgkmcnt(14)
    v_mfma_f32_32x32x16_bf16 v[144:159], v[160:163], v[192:195], v[144:159]
    ds_read_b128 v[160:163], v226 offset:1600
    ds_read_b128 v[192:195], v225 offset:1792
    s_waitcnt lgkmcnt(14)
    v_mfma_f32_32x32x16_bf16 v[144:159], v[164:167], v[196:199], v[144:159]
    ds_read_b128 v[164:167], v226 offset:1632
    ds_read_b128 v[196:199], v225 offset:1824
    s_waitcnt lgkmcnt(14)
    v_mfma_f32_32x32x16_bf16 v[144:159], v[168:171], v[200:203], v[144:159]
    ds_read_b128 v[168:171], v226 offset:1680
    ds_read_b128 v[200:203], v225 offset:1856
    s_waitcnt lgkmcnt(14)
    v_mfma_f32_32x32x16_bf16 v[144:159], v[172:175], v[204:207], v[144:159]
    ds_read_b128 v[172:175], v226 offset:1712
    ds_read_b128 v[204:207], v225 offset:1888
    s_waitcnt lgkmcnt(14)
    v_mfma_f32_32x32x16_bf16 v[144:159], v[176:179], v[208:211], v[144:159]
    ds_read_b128 v[176:179], v226 offset:1760
    ds_read_b128 v[208:211], v225 offset:1920
    s_waitcnt lgkmcnt(14)
    v_mfma_f32_32x32x16_bf16 v[144:159], v[180:183], v[212:215], v[144:159]
    ds_read_b128 v[180:183], v226 offset:1792
    ds_read_b128 v[212:215], v225 offset:1952
    s_waitcnt lgkmcnt(14)
    v_mfma_f32_32x32x16_bf16 v[144:159], v[184:187], v[216:219], v[144:159]
    ds_read_b128 v[184:187], v226 offset:1840
    ds_read_b128 v[216:219], v225 offset:1984
    s_waitcnt lgkmcnt(14)
    v_mfma_f32_32x32x16_bf16 v[144:159], v[188:191], v[220:223], v[144:159]
    ds_read_b128 v[188:191], v226 offset:1872
    ds_read_b128 v[220:223], v225 offset:2016
    s_waitcnt lgkmcnt(14)
    v_mfma_f32_32x32x16_bf16 v[144:159], v[160:163], v[192:195], v[144:159]
    ds_read_b128 v[160:163], v226 offset:1920
    ds_read_b128 v[192:195], v225 offset:2048
    s_waitcnt lgkmcnt(14)
    v_mfma_f32_32x32x16_bf16 v[144:159], v[164:167], v[196:199], v[144:159]
    ds_read_b128 v[164:167], v226 offset:1952
    ds_read_b128 v[196:199], v225 offset:2080
    s_waitcnt lgkmcnt(14)
    v_mfma_f32_32x32x16_bf16 v[144:159], v[168:171], v[200:203], v[144:159]
    ds_read_b128 v[168:171], v226 offset:2000
    ds_read_b128 v[200:203], v225 offset:2112
    s_waitcnt lgkmcnt(14)
    v_mfma_f32_32x32x16_bf16 v[144:159], v[172:175], v[204:207], v[144:159]
    ds_read_b128 v[172:175], v226 offset:2032
    ds_read_b128 v[204:207], v225 offset:2144
    s_waitcnt lgkmcnt(14)
    v_mfma_f32_32x32x16_bf16 v[144:159], v[176:179], v[208:211], v[144:159]
    ds_read_b128 v[176:179], v226 offset:2080
    ds_read_b128 v[208:211], v225 offset:2176
    s_waitcnt lgkmcnt(14)
    v_mfma_f32_32x32x16_bf16 v[144:159], v[180:183], v[212:215], v[144:159]
    ds_read_b128 v[180:183], v226 offset:2112
    ds_read_b128 v[212:215], v225 offset:2208
    s_waitcnt lgkmcnt(14)
    v_mfma_f32_32x32x16_bf16 v[144:159], v[184:187], v[216:219], v[144:159]
    ds_read_b128 v[184:187], v226 offset:2160
    ds_read_b128 v[216:219], v225 offset:2240
    s_waitcnt lgkmcnt(14)
    v_mfma_f32_32x32x16_bf16 v[144:159], v[188:191], v[220:223], v[144:159]
    ds_read_b128 v[188:191], v226 offset:2192
    ds_read_b128 v[220:223], v225 offset:2272
    s_waitcnt lgkmcnt(14)
    v_mfma_f32_32x32x16_bf16 v[144:159], v[160:163], v[192:195], v[144:159]
    ds_read_b128 v[160:163], v226 offset:2240
    ds_read_b128 v[192:195], v225 offset:2304
    s_waitcnt lgkmcnt(14)
    v_mfma_f32_32x32x16_bf16 v[144:159], v[164:167], v[196:199], v[144:159]
    ds_read_b128 v[164:167], v226 offset:2272
    ds_read_b128 v[196:199], v225 offset:2336
    s_waitcnt lgkmcnt(14)
    v_mfma_f32_32x32x16_bf16 v[144:159], v[168:171], v[200:203], v[144:159]
    ds_read_b128 v[168:171], v226 offset:2320
    ds_read_b128 v[200:203], v225 offset:2368
    s_waitcnt lgkmcnt(14)
    v_mfma_f32_32x32x16_bf16 v[144:159], v[172:175], v[204:207], v[144:159]
    ds_read_b128 v[172:175], v226 offset:2352
    ds_read_b128 v[204:207], v225 offset:2400
    s_waitcnt lgkmcnt(14)
    v_mfma_f32_32x32x16_bf16 v[144:159], v[176:179], v[208:211], v[144:159]
    ds_read_b128 v[176:179], v226 offset:2400
    ds_read_b128 v[208:211], v225 offset:2432
    s_waitcnt lgkmcnt(14)
    v_mfma_f32_32x32x16_bf16 v[144:159], v[180:183], v[212:215], v[144:159]
    ds_read_b128 v[180:183], v226 offset:2432
    ds_read_b128 v[212:215], v225 offset:2464
    s_waitcnt lgkmcnt(14)
    v_mfma_f32_32x32x16_bf16 v[144:159], v[184:187], v[216:219], v[144:159]
    ds_read_b128 v[184:187], v226 offset:2480
    ds_read_b128 v[216:219], v225 offset:2496
    s_waitcnt lgkmcnt(14)
    v_mfma_f32_32x32x16_bf16 v[144:159], v[188:191], v[220:223], v[144:159]
    ds_read_b128 v[188:191], v226 offset:2512
    ds_read_b128 v[220:223], v225 offset:2528
    s_waitcnt lgkmcnt(14)
    v_mfma_f32_32x32x16_bf16 v[144:159], v[160:163], v[192:195], v[144:159]
    ds_read_b128 v[160:163], v226 offset:2560
    ds_read_b128 v[192:195], v225 offset:2560
    s_waitcnt lgkmcnt(14)
    v_mfma_f32_32x32x16_bf16 v[144:159], v[164:167], v[196:199], v[144:159]
    ds_read_b128 v[164:167], v226 offset:2592
    ds_read_b128 v[196:199], v225 offset:2592
    s_waitcnt lgkmcnt(14)
    v_mfma_f32_32x32x16_bf16 v[144:159], v[168:171], v[200:203], v[144:159]
    s_waitcnt lgkmcnt(12)
    v_mfma_f32_32x32x16_bf16 v[144:159], v[172:175], v[204:207], v[144:159]
    s_waitcnt lgkmcnt(10)
    v_mfma_f32_32x32x16_bf16 v[144:159], v[176:179], v[208:211], v[144:159]
    s_waitcnt lgkmcnt(8)
    v_mfma_f32_32x32x16_bf16 v[144:159], v[180:183], v[212:215], v[144:159]
    s_waitcnt lgkmcnt(6)
    v_mfma_f32_32x32x16_bf16 v[144:159], v[184:187], v[216:219], v[144:159]
    s_waitcnt lgkmcnt(4)
    v_mfma_f32_32x32x16_bf16 v[144:159], v[188:191], v[220:223], v[144:159]
    s_waitcnt lgkmcnt(2)
    v_mfma_f32_32x32x16_bf16 v[144:159], v[160:163], v[192:195], v[144:159]
    s_waitcnt lgkmcnt(0)
    v_mfma_f32_32x32x16_bf16 v[144:159], v[164:167], v[196:199], v[144:159]
    v_and_b32 v2, 31, v1
    v_sub_u32 v2, 63, v2
    v_lshlrev_b32 v2, 2, v2
    v_lshrrev_b32 v3, 5, v1
    v_lshlrev_b32 v3, 10, v3
    v_add_u32 v2, v2, v3
    s_lshl_b32 s55, s50, 13
    s_add_u32 s55, s55, 122752
    v_add_u32 v2, s55, v2
    v_and_b32 v6, 31, v1
    v_sub_u32 v6, 31, v6
    v_lshlrev_b32 v6, 2, v6
    v_lshrrev_b32 v3, 5, v1
    v_lshlrev_b32 v3, 9, v3
    v_add_u32 v6, v6, v3
    s_lshr_b32 s55, s50, 1
    s_lshl_b32 s55, s55, 12
    s_add_u32 s55, s55, 155648
    v_add_u32 v6, s55, v6
    s_waitcnt lgkmcnt(0)
    s_nop 7
    s_nop 1
    ds_write_b32 v2, v16 offset:128
    ds_write_b32 v2, v17 offset:384
    ds_write_b32 v2, v18 offset:640
    ds_write_b32 v2, v19 offset:896
    ds_write_b32 v2, v20 offset:2176
    ds_write_b32 v2, v21 offset:2432
    ds_write_b32 v2, v22 offset:2688
    ds_write_b32 v2, v23 offset:2944
    ds_write_b32 v2, v24 offset:4224
    ds_write_b32 v2, v25 offset:4480
    ds_write_b32 v2, v26 offset:4736
    ds_write_b32 v2, v27 offset:4992
    ds_write_b32 v2, v28 offset:6272
    ds_write_b32 v2, v29 offset:6528
    ds_write_b32 v2, v30 offset:6784
    ds_write_b32 v2, v31 offset:7040
    ds_write_b32 v2, v32 offset:0
    ds_write_b32 v2, v33 offset:256
    ds_write_b32 v2, v34 offset:512
    ds_write_b32 v2, v35 offset:768
    ds_write_b32 v2, v36 offset:2048
    ds_write_b32 v2, v37 offset:2304
    ds_write_b32 v2, v38 offset:2560
    ds_write_b32 v2, v39 offset:2816
    ds_write_b32 v2, v40 offset:4096
    ds_write_b32 v2, v41 offset:4352
    ds_write_b32 v2, v42 offset:4608
    ds_write_b32 v2, v43 offset:4864
    ds_write_b32 v2, v44 offset:6144
    ds_write_b32 v2, v45 offset:6400
    ds_write_b32 v2, v46 offset:6656
    ds_write_b32 v2, v47 offset:6912
    ds_write_b32 v6, v144 offset:0
    ds_write_b32 v6, v145 offset:128
    ds_write_b32 v6, v146 offset:256
    ds_write_b32 v6, v147 offset:384
    ds_write_b32 v6, v148 offset:1024
    ds_write_b32 v6, v149 offset:1152
    ds_write_b32 v6, v150 offset:1280
    ds_write_b32 v6, v151 offset:1408
    ds_write_b32 v6, v152 offset:2048
    ds_write_b32 v6, v153 offset:2176
    ds_write_b32 v6, v154 offset:2304
    ds_write_b32 v6, v155 offset:2432
    ds_write_b32 v6, v156 offset:3072
    ds_write_b32 v6, v157 offset:3200
    ds_write_b32 v6, v158 offset:3328
    ds_write_b32 v6, v159 offset:3456
L_khj_20:
    s_lshl_b32 s58, s59, 16
    s_and_b32 s59, s59, 0xffff0000
    v_lshlrev_b32 v2, 4, v0
    v_add_u32 v3, 122880, v2
    v_add_u32 v10, 155648, v2
    v_lshlrev_b32 v4, 2, v0
    v_sub_u32 v4, 2044, v4
    v_lshrrev_b32 v6, 6, v4
    v_mul_u32_u24 v6, 144, v6
    v_and_b32 v4, 63, v4
    v_lshlrev_b32 v4, 1, v4
    v_add_u32 v4, v4, v6
    v_add_u32 v4, 70656, v4
    v_lshlrev_b32 v5, 2, v0
    v_sub_u32 v5, 1020, v5
    v_lshrrev_b32 v6, 6, v5
    v_mul_u32_u24 v6, 144, v6
    v_and_b32 v5, 63, v5
    v_lshlrev_b32 v5, 1, v5
    v_add_u32 v5, v5, v6
    v_add_u32 v5, 70656, v5
    ds_read_b64 v[48:49], v4
    ds_read_b64 v[50:51], v4 offset:9072
    ds_read_b64 v[52:53], v5
    ds_read_b64 v[54:55], v5 offset:9072
    s_lshl_b32 s55, s51, 13
    s_add_u32 s55, s55, 2162688
    s_add_u32 s56, s55, 4096
    s_waitcnt lgkmcnt(0)
    v_and_b32 v88, 0xffff0000, v49
    v_lshlrev_b32 v89, 16, v49
    v_and_b32 v90, 0xffff0000, v48
    v_lshlrev_b32 v91, 16, v48
    v_and_b32 v92, 0xffff0000, v51
    v_lshlrev_b32 v93, 16, v51
    v_and_b32 v94, 0xffff0000, v50
    v_lshlrev_b32 v95, 16, v50
    v_and_b32 v96, 0xffff0000, v53
    v_lshlrev_b32 v97, 16, v53
    v_and_b32 v98, 0xffff0000, v52
    v_lshlrev_b32 v99, 16, v52
    v_and_b32 v100, 0xffff0000, v55
    v_lshlrev_b32 v101, 16, v55
    v_and_b32 v102, 0xffff0000, v54
    v_lshlrev_b32 v103, 16, v54
    s_barrier
    ds_read_b128 v[16:19], v3 offset:0
    ds_read_b128 v[20:23], v3 offset:8192
    ds_read_b128 v[24:27], v3 offset:16384
    ds_read_b128 v[28:31], v3 offset:24576
    ds_read_b128 v[32:35], v3 offset:4096
    ds_read_b128 v[36:39], v3 offset:12288
    ds_read_b128 v[40:43], v3 offset:20480
    ds_read_b128 v[44:47], v3 offset:28672
    s_cmp_lg_u32 s50, 0
    s_cbranch_scc1 L_ap_22
    s_mov_b64 exec, 0xff
    s_lshl_b32 s52, s48, 3
    s_add_u32 s52, s52, 128
    v_add_u32 v12, s52, v1
    v_lshlrev_b32 v12, 8, v12
    buffer_load_dword v11, v12, s[40:43], 0 offen sc1
    s_mov_b64 exec, -1
L_ap_22:
    ds_read_b128 v[80:83], v10
    ds_read_b128 v[84:87], v10 offset:4096
    s_waitcnt lgkmcnt(6)
    v_pk_add_f32 v[16:17], v[16:17], v[20:21]
    v_pk_add_f32 v[18:19], v[18:19], v[22:23]
    v_pk_add_f32 v[24:25], v[24:25], v[28:29]
    v_pk_add_f32 v[26:27], v[26:27], v[30:31]
    v_pk_fma_f32 v[16:17], v[88:89], s[58:59], v[16:17] op_sel:[0,0,0] op_sel_hi:[1,0,1]
    v_pk_fma_f32 v[18:19], v[90:91], s[58:59], v[18:19] op_sel:[0,0,0] op_sel_hi:[1,0,1]
    v_pk_fma_f32 v[24:25], v[92:93], s[58:59], v[24:25] op_sel:[0,1,0] op_sel_hi:[1,1,1]
    v_pk_fma_f32 v[26:27], v[94:95], s[58:59], v[26:27] op_sel:[0,1,0] op_sel_hi:[1,1,1]
    v_cvt_pk_bf16_f32 v72, v16, v24
    v_cvt_pk_bf16_f32 v73, v17, v25
    v_cvt_pk_bf16_f32 v74, v18, v26
    v_cvt_pk_bf16_f32 v75, v19, v27
    buffer_store_dwordx4 v[72:75], v2, s[40:43], s55 offen sc1
    s_waitcnt lgkmcnt(0)
    v_pk_add_f32 v[32:33], v[32:33], v[36:37]
    v_pk_add_f32 v[34:35], v[34:35], v[38:39]
    v_pk_add_f32 v[40:41], v[40:41], v[44:45]
    v_pk_add_f32 v[42:43], v[42:43], v[46:47]
    v_pk_add_f32 v[32:33], v[32:33], v[80:81]
    v_pk_add_f32 v[34:35], v[34:35], v[82:83]
    v_pk_add_f32 v[40:41], v[40:41], v[84:85]
    v_pk_add_f32 v[42:43], v[42:43], v[86:87]
    v_pk_fma_f32 v[32:33], v[96:97], s[58:59], v[32:33] op_sel:[0,0,0] op_sel_hi:[1,0,1]
    v_pk_fma_f32 v[34:35], v[98:99], s[58:59], v[34:35] op_sel:[0,0,0] op_sel_hi:[1,0,1]
    v_pk_fma_f32 v[40:41], v[100:101], s[58:59], v[40:41] op_sel:[0,1,0] op_sel_hi:[1,1,1]
    v_pk_fma_f32 v[42:43], v[102:103], s[58:59], v[42:43] op_sel:[0,1,0] op_sel_hi:[1,1,1]
    v_cvt_pk_bf16_f32 v76, v32, v40
    v_cvt_pk_bf16_f32 v77, v33, v41
    v_cvt_pk_bf16_f32 v78, v34, v42
    v_cvt_pk_bf16_f32 v79, v35, v43
    buffer_store_dwordx4 v[76:79], v2, s[40:43], s56 offen sc1
    s_cmp_lg_u32 s50, 0
    s_cbranch_scc1 L_aok_23
    s_waitcnt vmcnt(2)
    s_mov_b64 exec, 0xff
    v_cmp_le_u32 vcc, 32, v11
    s_mov_b64 exec, -1
    s_cmp_eq_u64 vcc, 0xff
    s_cbranch_scc1 L_aok_23
    s_cmp_lg_u32 s50, 0
    s_cbranch_scc1 L_pr_24
    s_mov_b64 exec, 0xff
    s_lshl_b32 s52, s48, 3
    s_add_u32 s52, s52, 128
    v_add_u32 v4, s52, v1
    v_lshlrev_b32 v4, 8, v4
    s_mov_b32 s60, 0
L_sp_25:
    buffer_load_dword v3, v4, s[40:43], 0 offen sc1
    s_waitcnt vmcnt(0)
    s_add_u32 s60, s60, 1
    v_cmp_le_u32 vcc, 32, v3
    s_nop 0
    s_cmp_eq_u64 vcc, 0xff
    s_cbranch_scc1 L_spok_26
    s_cmp_lt_u32 s60, 20000
    s_cbranch_scc1 L_sp_25
L_spok_26:
    s_mov_b64 exec, -1
L_pr_24:
L_aok_23:
    s_barrier
    s_mov_b32 s67, 0
    s_mov_b32 s68, 11075584
    s_mov_b32 s69, 15269888
    s_mov_b32 s70, 10027008
    s_mov_b32 s71, 10289152
    s_mov_b32 s79, 192
    v_lshlrev_b32 v2, 4, v1
    s_mul_i32 s73, s66, 229376
    s_lshl_b32 s74, s50, 12
    s_add_u32 s73, s73, s74
    s_add_u32 s73, s73, 4259840
    s_mul_i32 s77, s67, 98304
    s_sub_u32 s77, s73, s77
    s_add_u32 m0, s74, 0
    s_add_u32 s75, s73, 0
    buffer_load_dwordx4 v2, s[40:43], s75 offen offset:0 sc1 lds
    buffer_load_dwordx4 v2, s[40:43], s75 offen offset:1024 sc1 lds
    buffer_load_dwordx4 v2, s[40:43], s75 offen offset:2048 sc1 lds
    buffer_load_dwordx4 v2, s[40:43], s75 offen offset:3072 sc1 lds
    s_add_u32 m0, s74, 16384
    s_add_u32 s75, s73, 32768
    buffer_load_dwordx4 v2, s[40:43], s75 offen offset:0 sc1 lds
    buffer_load_dwordx4 v2, s[40:43], s75 offen offset:1024 sc1 lds
    buffer_load_dwordx4 v2, s[40:43], s75 offen offset:2048 sc1 lds
    buffer_load_dwordx4 v2, s[40:43], s75 offen offset:3072 sc1 lds
    s_add_u32 m0, s74, 32768
    s_add_u32 s75, s73, 65536
    buffer_load_dwordx4 v2, s[40:43], s75 offen offset:0 sc1 lds
    buffer_load_dwordx4 v2, s[40:43], s75 offen offset:1024 sc1 lds
    buffer_load_dwordx4 v2, s[40:43], s75 offen offset:2048 sc1 lds
    buffer_load_dwordx4 v2, s[40:43], s75 offen offset:3072 sc1 lds
    v_lshrrev_b32 v3, 5, v0
    v_min_u32 v3, 6, v3
    v_and_b32 v4, 31, v0
    v_lshlrev_b32 v5, 8, v3
    v_lshlrev_b32 v6, 2, v4
    v_add_u32 v5, v5, v6
    s_mul_i32 s55, s66, 1792
    s_add_u32 s55, s55, 9764864
    buffer_load_dword v96, v5, s[40:43], s55 offen sc1
    buffer_load_dword v97, v5, s[40:43], s55 offen offset:128 sc1
    s_add_u32 s55, s55, 28672
    buffer_load_dword v98, v5, s[40:43], s55 offen sc1
    buffer_load_dword v99, v5, s[40:43], s55 offen offset:128 sc1
    s_add_u32 s55, s55, 28672
    buffer_load_dword v100, v5, s[40:43], s55 offen sc1
    buffer_load_dword v101, v5, s[40:43], s55 offen offset:128 sc1
    s_add_u32 s55, s55, 28672
    buffer_load_dword v102, v5, s[40:43], s55 offen sc1
    buffer_load_dword v103, v5, s[40:43], s55 offen offset:128 sc1
    s_add_u32 s55, s55, 28672
    buffer_load_dword v104, v5, s[40:43], s55 offen sc1
    buffer_load_dword v105, v5, s[40:43], s55 offen offset:128 sc1
    s_add_u32 s55, s55, 28672
    buffer_load_dword v106, v5, s[40:43], s55 offen sc1
    buffer_load_dword v107, v5, s[40:43], s55 offen offset:128 sc1
    s_add_u32 s55, s55, 28672
    buffer_load_dword v108, v5, s[40:43], s55 offen sc1
    buffer_load_dword v109, v5, s[40:43], s55 offen offset:128 sc1
    s_add_u32 s55, s55, 28672
    buffer_load_dword v110, v5, s[40:43], s55 offen sc1
    buffer_load_dword v111, v5, s[40:43], s55 offen offset:128 sc1
    v_lshlrev_b32 v128, 16, v64
    v_and_b32 v129, 0xffff0000, v64
    v_lshlrev_b32 v130, 16, v65
    v_and_b32 v131, 0xffff0000, v65
    v_lshlrev_b32 v132, 16, v66
    v_and_b32 v133, 0xffff0000, v66
    v_lshlrev_b32 v134, 16, v67
    v_and_b32 v135, 0xffff0000, v67
    v_lshlrev_b32 v136, 16, v68
    v_and_b32 v137, 0xffff0000, v68
    v_lshlrev_b32 v138, 16, v69
    v_and_b32 v139, 0xffff0000, v69
    v_lshlrev_b32 v140, 16, v70
    v_and_b32 v141, 0xffff0000, v70
    v_lshlrev_b32 v142, 16, v71
    v_and_b32 v143, 0xffff0000, v71
L_layer:
    v_and_b32 v4, 31, v1
    v_lshlrev_b32 v5, 3, v4
    v_lshrrev_b32 v3, 5, v1
    v_lshlrev_b32 v6, 17, v3
    v_add_u32 v5, v5, v6
    v_lshlrev_b32 v4, 2, v4
    v_lshlrev_b32 v3, 15, v3
    v_add_u32 v4, v4, v3
    s_lshl_b32 s75, s64, 8
    s_add_u32 s75, s75, s70
    s_lshl_b32 s76, s63, 17
    s_lshl_b32 s56, s64, 7
    s_add_u32 s76, s76, s56
    s_add_u32 s76, s76, 2162688
    s_lshl_b32 s26, s64, 15
    s_lshl_b32 s56, s63, 11
    s_add_u32 s26, s26, s56
    s_add_u32 s26, s26, s68
    s_cmp_eq_u32 s67, 0
    s_cbranch_scc1 L_yu_27
    v_accvgpr_read_b32 v56, a224
    v_accvgpr_read_b32 v57, a225
    v_accvgpr_read_b32 v58, a226
    v_accvgpr_read_b32 v59, a227
    v_accvgpr_read_b32 v60, a228
    v_accvgpr_read_b32 v61, a229
    v_accvgpr_read_b32 v62, a230
    v_accvgpr_read_b32 v63, a231
    v_lshlrev_b32 v64, 16, v56
    v_and_b32 v65, 0xffff0000, v56
    v_lshlrev_b32 v66, 16, v57
    v_and_b32 v67, 0xffff0000, v57
    v_lshlrev_b32 v68, 16, v58
    v_and_b32 v69, 0xffff0000, v58
    v_lshlrev_b32 v70, 16, v59
    v_and_b32 v71, 0xffff0000, v59
    v_lshlrev_b32 v72, 16, v60
    v_and_b32 v73, 0xffff0000, v60
    v_lshlrev_b32 v74, 16, v61
    v_and_b32 v75, 0xffff0000, v61
    v_lshlrev_b32 v76, 16, v62
    v_and_b32 v77, 0xffff0000, v62
    v_lshlrev_b32 v78, 16, v63
    v_and_b32 v79, 0xffff0000, v63
L_yu_27:
    s_mov_b32 s60, 0
L_sp_28:
    s_add_u32 s56, s75, 0
    buffer_load_dwordx2 v[16:17], v5, s[40:43], s56 offen sc1
    s_add_u32 s56, s75, 16384
    buffer_load_dwordx2 v[18:19], v5, s[40:43], s56 offen sc1
    s_add_u32 s56, s75, 32768
    buffer_load_dwordx2 v[20:21], v5, s[40:43], s56 offen sc1
    s_add_u32 s56, s75, 49152
    buffer_load_dwordx2 v[22:23], v5, s[40:43], s56 offen sc1
    s_add_u32 s56, s75, 65536
    buffer_load_dwordx2 v[24:25], v5, s[40:43], s56 offen sc1
    s_add_u32 s56, s75, 81920
    buffer_load_dwordx2 v[26:27], v5, s[40:43], s56 offen sc1
    s_add_u32 s56, s75, 98304
    buffer_load_dwordx2 v[28:29], v5, s[40:43], s56 offen sc1
    s_add_u32 s56, s75, 114688
    buffer_load_dwordx2 v[30:31], v5, s[40:43], s56 offen sc1
    s_cmp_lg_u32 s67, 0
    s_cbranch_scc1 L_ny_30
    s_add_u32 s56, s76, 0
    buffer_load_dword v32, v4, s[40:43], s56 offen sc1
    s_add_u32 s56, s76, 8192
    buffer_load_dword v33, v4, s[40:43], s56 offen sc1
    s_add_u32 s56, s76, 16384
    buffer_load_dword v34, v4, s[40:43], s56 offen sc1
    s_add_u32 s56, s76, 24576
    buffer_load_dword v35, v4, s[40:43], s56 offen sc1
    s_add_u32 s56, s76, 65536
    buffer_load_dword v36, v4, s[40:43], s56 offen sc1
    s_add_u32 s56, s76, 73728
    buffer_load_dword v37, v4, s[40:43], s56 offen sc1
    s_add_u32 s56, s76, 81920
    buffer_load_dword v38, v4, s[40:43], s56 offen sc1
    s_add_u32 s56, s76, 90112
    buffer_load_dword v39, v4, s[40:43], s56 offen sc1
L_ny_30:
    s_waitcnt vmcnt(0)
    s_add_u32 s60, s60, 1
    v_and_b32 v3, v17, v19
    v_and_b32 v3, v3, v21
    v_and_b32 v3, v3, v23
    v_and_b32 v3, v3, v25
    v_and_b32 v3, v3, v27
    v_and_b32 v3, v3, v29
    v_and_b32 v3, v3, v31
    v_and_b32 v3, 1, v3
    v_cmp_ne_u32 vcc, 1, v3
    s_cmp_lg_u32 s67, 0
    s_cbranch_scc1 L_ny_31
    v_max3_u32 v3, v32, v33, v34
    v_max3_u32 v3, v3, v35, v36
    v_max3_u32 v3, v3, v37, v38
    v_max_u32 v3, v3, v39
    v_cmp_eq_u32 s[52:53], -1, v3
    s_nop 1
    s_or_b64 vcc, vcc, s[52:53]
L_ny_31:
    s_nop 0
    s_cmp_eq_u64 vcc, 0
    s_cbranch_scc1 L_spok_29
    s_cmp_lt_u32 s60, 20000
    s_cbranch_scc1 L_sp_28
L_spok_29:
    s_cmp_lg_u32 s67, 0
    s_cbranch_scc1 L_ny_32
    v_accvgpr_write_b32 a224, v32
    v_accvgpr_write_b32 a225, v33
    v_accvgpr_write_b32 a226, v34
    v_accvgpr_write_b32 a227, v35
    v_accvgpr_write_b32 a228, v36
    v_accvgpr_write_b32 a229, v37
    v_accvgpr_write_b32 a230, v38
    v_accvgpr_write_b32 a231, v39
    v_lshlrev_b32 v64, 16, v32
    v_and_b32 v65, 0xffff0000, v32
    v_lshlrev_b32 v66, 16, v33
    v_and_b32 v67, 0xffff0000, v33
    v_lshlrev_b32 v68, 16, v34
    v_and_b32 v69, 0xffff0000, v34
    v_lshlrev_b32 v70, 16, v35
    v_and_b32 v71, 0xffff0000, v35
    v_lshlrev_b32 v72, 16, v36
    v_and_b32 v73, 0xffff0000, v36
    v_lshlrev_b32 v74, 16, v37
    v_and_b32 v75, 0xffff0000, v37
    v_lshlrev_b32 v76, 16, v38
    v_and_b32 v77, 0xffff0000, v38
    v_lshlrev_b32 v78, 16, v39
    v_and_b32 v79, 0xffff0000, v39
L_ny_32:
    v_pk_add_f32 v[16:17], v[16:17], v[18:19]
    v_pk_add_f32 v[20:21], v[20:21], v[22:23]
    v_pk_add_f32 v[24:25], v[24:25], v[26:27]
    v_pk_add_f32 v[28:29], v[28:29], v[30:31]
    v_pk_add_f32 v[16:17], v[16:17], v[20:21]
    v_pk_add_f32 v[24:25], v[24:25], v[28:29]
    v_pk_add_f32 v[8:9], v[16:17], v[24:25]
    v_mov_b32 v11, v8
    v_mov_b32 v12, v9
    v_lshlrev_b32 v2, 4, v1
    s_nop 0
    v_permlane32_swap_b32 v8, v11
    v_permlane32_swap_b32 v9, v12
    s_nop 0
    v_add_f32 v8, v8, v11
    v_add_f32 v9, v9, v12
    v_mul_f32 v8, 0xbb000000, v8
    v_mul_f32 v9, 0x3b000000, v9
    v_fma_f32 v9, -v8, v8, v9
    v_max_f32 v9, 0, v9
    v_add_f32 v9, 0x3727c5ac, v9
    v_rsq_f32 v10, v9
    s_nop 0
    v_mul_f32 v8, v8, v10
    s_nop 0
    v_pk_fma_f32 v[48:49], v[128:129], v[10:11], v[8:9] op_sel_hi:[1,0,0]
    v_pk_fma_f32 v[50:51], v[130:131], v[10:11], v[8:9] op_sel_hi:[1,0,0]
    v_pk_fma_f32 v[52:53], v[132:133], v[10:11], v[8:9] op_sel_hi:[1,0,0]
    v_pk_fma_f32 v[54:55], v[134:135], v[10:11], v[8:9] op_sel_hi:[1,0,0]
    v_pk_fma_f32 v[56:57], v[136:137], v[10:11], v[8:9] op_sel_hi:[1,0,0]
    v_pk_fma_f32 v[58:59], v[138:139], v[10:11], v[8:9] op_sel_hi:[1,0,0]
    v_pk_fma_f32 v[60:61], v[140:141], v[10:11], v[8:9] op_sel_hi:[1,0,0]
    v_pk_fma_f32 v[62:63], v[142:143], v[10:11], v[8:9] op_sel_hi:[1,0,0]
    v_pk_fma_f32 v[128:129], v[48:49], v[64:65], v[128:129]
    v_pk_fma_f32 v[130:131], v[50:51], v[66:67], v[130:131]
    v_pk_fma_f32 v[132:133], v[52:53], v[68:69], v[132:133]
    v_pk_fma_f32 v[134:135], v[54:55], v[70:71], v[134:135]
    v_pk_fma_f32 v[136:137], v[56:57], v[72:73], v[136:137]
    v_pk_fma_f32 v[138:139], v[58:59], v[74:75], v[138:139]
    v_pk_fma_f32 v[140:141], v[60:61], v[76:77], v[140:141]
    v_pk_fma_f32 v[142:143], v[62:63], v[78:79], v[142:143]
    v_cvt_pk_bf16_f32 v16, v128, v129
    v_cvt_pk_bf16_f32 v17, v130, v131
    v_cvt_pk_bf16_f32 v18, v132, v133
    v_cvt_pk_bf16_f32 v19, v134, v135
    buffer_store_dwordx4 v[16:19], v2, s[40:43], s26 offen sc1
    v_cvt_pk_bf16_f32 v20, v136, v137
    v_cvt_pk_bf16_f32 v21, v138, v139
    v_cvt_pk_bf16_f32 v22, v140, v141
    v_cvt_pk_bf16_f32 v23, v142, v143
    buffer_store_dwordx4 v[20:23], v2, s[40:43], s26 offen offset:1024 sc1
    v_mov_b32 v10, 0x3f803f80
    v_mov_b32 v8, 0
    v_mov_b32 v9, 0
    v_dot2_f32_bf16 v8, v16, v10, v8
    v_dot2_f32_bf16 v9, v16, v16, v9
    v_dot2_f32_bf16 v8, v17, v10, v8
    v_dot2_f32_bf16 v9, v17, v17, v9
    v_dot2_f32_bf16 v8, v18, v10, v8
    v_dot2_f32_bf16 v9, v18, v18, v9
    v_dot2_f32_bf16 v8, v19, v10, v8
    v_dot2_f32_bf16 v9, v19, v19, v9
    v_dot2_f32_bf16 v8, v20, v10, v8
    v_dot2_f32_bf16 v9, v20, v20, v9
    v_dot2_f32_bf16 v8, v21, v10, v8
    v_dot2_f32_bf16 v9, v21, v21, v9
    v_dot2_f32_bf16 v8, v22, v10, v8
    v_dot2_f32_bf16 v9, v22, v22, v9
    v_dot2_f32_bf16 v8, v23, v10, v8
    v_dot2_f32_bf16 v9, v23, v23, v9
    v_mov_b32 v11, v8
    v_mov_b32 v12, v9
    v_lshlrev_b32 v2, 3, v1
    s_lshl_b32 s55, s63, 14
    s_lshl_b32 s56, s64, 8
    s_add_u32 s55, s55, s56
    v_permlane32_swap_b32 v8, v11
    v_permlane32_swap_b32 v9, v12
    s_add_u32 s56, s55, s71
    v_add_f32 v8, v8, v11
    v_add_f32 v9, v9, v12
    v_or_b32 v9, 1, v9
    s_mov_b64 exec, 0xffffffff
    buffer_store_dwordx2 v[8:9], v2, s[40:43], s56 offen sc1
    s_mov_b64 exec, -1
    v_accvgpr_write_b32 a232, v16
    v_accvgpr_write_b32 a233, v17
    v_accvgpr_write_b32 a234, v18
    v_accvgpr_write_b32 a235, v19
    v_accvgpr_write_b32 a236, v20
    v_accvgpr_write_b32 a237, v21
    v_accvgpr_write_b32 a238, v22
    v_accvgpr_write_b32 a239, v23
    s_barrier
    v_lshlrev_b32 v2, 4, v1
    s_mul_i32 s73, s66, 229376
    s_lshl_b32 s74, s50, 12
    s_add_u32 s73, s73, s74
    s_add_u32 s73, s73, 4259840
    s_mul_i32 s77, s67, 98304
    s_sub_u32 s77, s73, s77
    s_cmp_lg_u32 s67, 0
    s_cbranch_scc1 L_l0_33
    s_add_u32 m0, s74, 49152
    s_add_u32 s75, s73, 16384
    buffer_load_dwordx4 v2, s[40:43], s75 offen offset:0 sc1 lds
    buffer_load_dwordx4 v2, s[40:43], s75 offen offset:1024 sc1 lds
    buffer_load_dwordx4 v2, s[40:43], s75 offen offset:2048 sc1 lds
    buffer_load_dwordx4 v2, s[40:43], s75 offen offset:3072 sc1 lds
    s_add_u32 m0, s74, 65536
    s_add_u32 s75, s73, 49152
    buffer_load_dwordx4 v2, s[40:43], s75 offen offset:0 sc1 lds
    buffer_load_dwordx4 v2, s[40:43], s75 offen offset:1024 sc1 lds
    buffer_load_dwordx4 v2, s[40:43], s75 offen offset:2048 sc1 lds
    buffer_load_dwordx4 v2, s[40:43], s75 offen offset:3072 sc1 lds
    s_add_u32 m0, s74, 81920
    s_add_u32 s75, s73, 81920
    buffer_load_dwordx4 v2, s[40:43], s75 offen offset:0 sc1 lds
    buffer_load_dwordx4 v2, s[40:43], s75 offen offset:1024 sc1 lds
    buffer_load_dwordx4 v2, s[40:43], s75 offen offset:2048 sc1 lds
    buffer_load_dwordx4 v2, s[40:43], s75 offen offset:3072 sc1 lds
    v_cmp_gt_u32 vcc, 224, v0
    v_lshrrev_b32 v3, 5, v0
    s_and_saveexec_b64 s[52:53], vcc
    v_and_b32 v4, 31, v0
    v_lshlrev_b32 v5, 10, v3
    v_lshlrev_b32 v6, 4, v4
    v_add_u32 v5, v5, v6
    v_add_u32 v5, 147456, v5
    v_add_f32 v96, v96, v97
    v_add_f32 v96, v96, v98
    v_add_f32 v96, v96, v99
    v_add_f32 v96, v96, v100
    v_add_f32 v96, v96, v101
    v_add_f32 v96, v96, v102
    v_add_f32 v96, v96, v103
    v_add_f32 v96, v96, v104
    v_add_f32 v96, v96, v105
    v_add_f32 v96, v96, v106
    v_add_f32 v96, v96, v107
    v_add_f32 v96, v96, v108
    v_add_f32 v96, v96, v109
    v_add_f32 v96, v96, v110
    v_add_f32 v96, v96, v111
    v_cvt_pk_bf16_f32 v101, v96, v96
    v_and_b32 v97, 0xffff0000, v101
    v_sub_f32 v97, v96, v97
    v_cvt_pk_bf16_f32 v100, v96, v97
    v_and_b32 v101, 0xffff, v101
    v_mov_b32 v102, 0
    v_mov_b32 v103, 0
    v_mov_b32 v104, 0
    v_mov_b32 v105, 0
    v_mov_b32 v106, 0
    v_mov_b32 v107, 0
    ds_write_b128 v5, v[100:103]
    ds_write_b128 v5, v[104:107] offset:512
    v_cmp_gt_u32 vcc, 4, v3
    s_nop 0
    s_and_b64 exec, exec, vcc
    ds_write_b128 v5, v[100:103] offset:7168
    ds_write_b128 v5, v[104:107] offset:7680
    s_mov_b64 exec, s[52:53]
L_l0_33:
    s_add_u32 m0, s74, 98304
    s_add_u32 s75, s77, 98304
    buffer_load_dwordx4 v2, s[40:43], s75 offen offset:0 sc1 lds
    buffer_load_dwordx4 v2, s[40:43], s75 offen offset:1024 sc1 lds
    buffer_load_dwordx4 v2, s[40:43], s75 offen offset:2048 sc1 lds
    buffer_load_dwordx4 v2, s[40:43], s75 offen offset:3072 sc1 lds
    s_add_u32 m0, s74, 114688
    s_add_u32 s75, s77, 114688
    buffer_load_dwordx4 v2, s[40:43], s75 offen offset:0 sc1 lds
    buffer_load_dwordx4 v2, s[40:43], s75 offen offset:1024 sc1 lds
    buffer_load_dwordx4 v2, s[40:43], s75 offen offset:2048 sc1 lds
    buffer_load_dwordx4 v2, s[40:43], s75 offen offset:3072 sc1 lds
    s_lshl_b32 s78, s72, 15
    s_add_u32 s78, s78, s68
    v_and_b32 v3, 15, v1
    v_lshlrev_b32 v4, 11, v3
    v_add_u32 v4, 2032, v4
    v_add_u32 v4, s78, v4
    v_lshlrev_b32 v5, 14, v3
    s_lshl_b32 s55, s72, 8
    s_add_u32 s55, s55, s71
    s_add_u32 s56, s55, 252
    v_add_u32 v5, s56, v5
    v_cmp_gt_u32 vcc, 16, v1
    s_nop 1
    v_cndmask_b32 v4, v5, v4, vcc
    s_waitcnt vmcnt(0) lgkmcnt(0)
    s_barrier
    s_mov_b64 exec, 0xffffffff
    s_mov_b32 s60, 0
L_sp_34:
    buffer_load_dword v3, v4, s[40:43], 0 offen sc1
    s_waitcnt vmcnt(0)
    s_add_u32 s60, s60, 1
    v_cmp_ne_u32 s[52:53], -1, v3
    v_and_b32 v3, 1, v3
    v_cmp_eq_u32 vcc, 1, v3
    s_nop 1
    s_and_b64 s[52:53], s[52:53], 0xffff
    s_and_b64 vcc, vcc, 0xffff0000
    s_or_b64 vcc, vcc, s[52:53]
    s_cmp_eq_u64 vcc, 0xffffffff
    s_cbranch_scc1 L_spok_35
    s_cmp_lt_u32 s60, 20000
    s_cbranch_scc1 L_sp_34
L_spok_35:
    s_mov_b64 exec, -1
    s_add_u32 s54, s78, 0
    buffer_load_dwordx4 v[16:19], v2, s[40:43], s54 offen offset:0 sc1
    buffer_load_dwordx4 v[20:23], v2, s[40:43], s54 offen offset:1024 sc1
    buffer_load_dwordx4 v[24:27], v2, s[40:43], s54 offen offset:2048 sc1
    buffer_load_dwordx4 v[28:31], v2, s[40:43], s54 offen offset:3072 sc1
    v_and_b32 v3, 31, v1
    v_lshlrev_b32 v3, 3, v3
    v_lshrrev_b32 v4, 5, v1
    v_lshlrev_b32 v4, 17, v4
    v_add_u32 v3, v3, v4
    s_add_u32 s56, s55, 0
    buffer_load_dwordx2 v[192:193], v3, s[40:43], s56 offen sc1
    s_add_u32 s56, s55, 16384
    buffer_load_dwordx2 v[194:195], v3, s[40:43], s56 offen sc1
    s_add_u32 s56, s55, 32768
    buffer_load_dwordx2 v[196:197], v3, s[40:43], s56 offen sc1
    s_add_u32 s56, s55, 49152
    buffer_load_dwordx2 v[198:199], v3, s[40:43], s56 offen sc1
    s_add_u32 s56, s55, 65536
    buffer_load_dwordx2 v[200:201], v3, s[40:43], s56 offen sc1
    s_add_u32 s56, s55, 81920
    buffer_load_dwordx2 v[202:203], v3, s[40:43], s56 offen sc1
    s_add_u32 s56, s55, 98304
    buffer_load_dwordx2 v[204:205], v3, s[40:43], s56 offen sc1
    s_add_u32 s56, s55, 114688
    buffer_load_dwordx2 v[206:207], v3, s[40:43], s56 offen sc1
    s_add_u32 s54, s78, 4096
    buffer_load_dwordx4 v[32:35], v2, s[40:43], s54 offen offset:0 sc1
    buffer_load_dwordx4 v[36:39], v2, s[40:43], s54 offen offset:1024 sc1
    buffer_load_dwordx4 v[40:43], v2, s[40:43], s54 offen offset:2048 sc1
    buffer_load_dwordx4 v[44:47], v2, s[40:43], s54 offen offset:3072 sc1
    s_add_u32 s54, s78, 8192
    buffer_load_dwordx4 v[48:51], v2, s[40:43], s54 offen offset:0 sc1
    buffer_load_dwordx4 v[52:55], v2, s[40:43], s54 offen offset:1024 sc1
    buffer_load_dwordx4 v[56:59], v2, s[40:43], s54 offen offset:2048 sc1
    buffer_load_dwordx4 v[60:63], v2, s[40:43], s54 offen offset:3072 sc1
    v_mov_b32 v4, v2
    v_add_u32 v5, 0x10000, v2
    s_lshl_b32 s56, s67, 12
    s_add_u32 s56, s56, 147456
    v_add_u32 v6, s56, v2
    s_mul_i32 s76, s72, 114688
    s_mul_i32 s56, s66, 7168
    s_add_u32 s76, s76, s56
    s_add_u32 s76, s76, s69
    s_mul_i32 s56, s67, 3072
    s_sub_u32 s57, s76, s56
    s_lshl_b32 s56, s67, 12
    s_add_u32 s76, s76, s56
    v_and_b32 v3, 15, v1
    s_lshl_b32 s56, s65, 1
    v_lshrrev_b32 v15, 3, v3
    v_add_u32 v15, s56, v15
    v_and_b32 v3, 7, v3
    v_and_b32 v7, 3, v15
    v_lshlrev_b32 v7, 3, v7
    v_or_b32 v7, v7, v3
    v_lshrrev_b32 v15, 2, v15
    v_lshl_add_u32 v15, v7, 3, v15
    v_lshlrev_b32 v15, 10, v15
    v_bfe_u32 v3, v1, 4, 1
    v_lshl_add_u32 v15, v3, 7, v15
    s_lshl_b32 s56, s67, 9
    s_add_u32 s56, s56, 30670848
    v_add_u32 v15, s56, v15
    ds_read_b128 v[208:211], v4 offset:0
    ds_read_b128 v[212:215], v4 offset:16384
    ds_read_b128 v[216:219], v4 offset:32768
    ds_read_b128 v[220:223], v4 offset:1024
    ds_read_b128 v[224:227], v4 offset:17408
    ds_read_b128 v[228:231], v4 offset:33792
    s_waitcnt vmcnt(16)
    v_max3_u32 v7, v16, v17, v18
    v_max3_u32 v7, v7, v19, v20
    v_max3_u32 v7, v7, v21, v22
    v_max3_u32 v7, v7, v23, v24
    v_max3_u32 v7, v7, v25, v26
    v_max3_u32 v7, v7, v27, v28
    v_max3_u32 v7, v7, v29, v30
    v_max_u32 v7, v7, v31
    v_cmp_eq_u32 vcc, -1, v7
    s_nop 1
    s_cbranch_vccnz L_rt_36
L_bk_37:
    s_waitcnt lgkmcnt(4)
    v_mfma_f32_32x32x16_bf16 v[144:159], v[208:211], v[16:19], 0
    ds_read_b128 v[232:235], v4 offset:2048
    v_mfma_f32_32x32x16_bf16 v[160:175], v[212:215], v[16:19], 0
    ds_read_b128 v[236:239], v4 offset:18432
    s_add_u32 s54, s78, 12288
    buffer_load_dwordx4 v[64:67], v2, s[40:43], s54 offen offset:0 sc1
    s_waitcnt lgkmcnt(4)
    v_mfma_f32_32x32x16_bf16 v[176:191], v[216:219], v[16:19], 0
    ds_read_b128 v[208:211], v4 offset:34816
    v_mfma_f32_32x32x16_bf16 v[144:159], v[220:223], v[20:23], v[144:159]
    ds_read_b128 v[212:215], v4 offset:3072
    s_waitcnt lgkmcnt(4)
    v_mfma_f32_32x32x16_bf16 v[160:175], v[224:227], v[20:23], v[160:175]
    ds_read_b128 v[216:219], v4 offset:19456
    buffer_load_dwordx4 v[68:71], v2, s[40:43], s54 offen offset:1024 sc1
    v_mfma_f32_32x32x16_bf16 v[176:191], v[228:231], v[20:23], v[176:191]
    ds_read_b128 v[220:223], v4 offset:35840
    s_waitcnt lgkmcnt(4)
    v_mfma_f32_32x32x16_bf16 v[144:159], v[232:235], v[24:27], v[144:159]
    ds_read_b128 v[224:227], v4 offset:4096
    v_mfma_f32_32x32x16_bf16 v[160:175], v[236:239], v[24:27], v[160:175]
    ds_read_b128 v[228:231], v4 offset:20480
    buffer_load_dwordx4 v[72:75], v2, s[40:43], s54 offen offset:2048 sc1
    s_waitcnt lgkmcnt(4)
    v_mfma_f32_32x32x16_bf16 v[176:191], v[208:211], v[24:27], v[176:191]
    ds_read_b128 v[232:235], v4 offset:36864
    v_mfma_f32_32x32x16_bf16 v[144:159], v[212:215], v[28:31], v[144:159]
    ds_read_b128 v[236:239], v4 offset:5120
    s_waitcnt lgkmcnt(4)
    v_mfma_f32_32x32x16_bf16 v[160:175], v[216:219], v[28:31], v[160:175]
    ds_read_b128 v[208:211], v4 offset:21504
    buffer_load_dwordx4 v[76:79], v2, s[40:43], s54 offen offset:3072 sc1
    v_mfma_f32_32x32x16_bf16 v[176:191], v[220:223], v[28:31], v[176:191]
    ds_read_b128 v[212:215], v4 offset:37888
    s_waitcnt vmcnt(8)
    v_max3_u32 v7, v32, v33, v34
    v_max3_u32 v7, v7, v35, v36
    v_max3_u32 v7, v7, v37, v38
    v_max3_u32 v7, v7, v39, v40
    v_max3_u32 v7, v7, v41, v42
    v_max3_u32 v7, v7, v43, v44
    v_max3_u32 v7, v7, v45, v46
    v_max_u32 v7, v7, v47
    v_cmp_eq_u32 vcc, -1, v7
    s_nop 1
    s_cbranch_vccnz L_rt_39
L_bk_40:
    s_waitcnt lgkmcnt(4)
    v_mfma_f32_32x32x16_bf16 v[144:159], v[224:227], v[32:35], v[144:159]
    ds_read_b128 v[216:219], v4 offset:6144
    v_mfma_f32_32x32x16_bf16 v[160:175], v[228:231], v[32:35], v[160:175]
    ds_read_b128 v[220:223], v4 offset:22528
    s_add_u32 s54, s78, 16384
    buffer_load_dwordx4 v[80:83], v2, s[40:43], s54 offen offset:0 sc1
    s_waitcnt vmcnt(13)
    s_waitcnt lgkmcnt(4)
    v_mfma_f32_32x32x16_bf16 v[176:191], v[232:235], v[32:35], v[176:191]
    ds_read_b128 v[224:227], v4 offset:38912
    v_and_b32 v7, v193, v195
    v_and_b32 v7, v7, v197
    v_and_b32 v7, v7, v199
    v_and_b32 v7, v7, v201
    v_and_b32 v7, v7, v203
    v_and_b32 v7, v7, v205
    v_and_b32 v7, v7, v207
    v_and_b32 v7, 1, v7
    v_cmp_ne_u32 vcc, 1, v7
    s_nop 1
    s_cbranch_vccnz L_rt_42
L_bk_43:
    v_mfma_f32_32x32x16_bf16 v[144:159], v[236:239], v[36:39], v[144:159]
    ds_read_b128 v[228:231], v4 offset:7168
    v_add_f32 v8, v192, v194
    v_add_f32 v9, v193, v195
    v_add_f32 v8, v8, v196
    v_add_f32 v9, v9, v197
    s_waitcnt lgkmcnt(4)
    v_mfma_f32_32x32x16_bf16 v[160:175], v[208:211], v[36:39], v[160:175]
    ds_read_b128 v[232:235], v4 offset:23552
    buffer_load_dwordx4 v[84:87], v2, s[40:43], s54 offen offset:1024 sc1
    v_add_f32 v8, v8, v198
    v_add_f32 v9, v9, v199
    v_add_f32 v8, v8, v200
    v_mfma_f32_32x32x16_bf16 v[176:191], v[212:215], v[36:39], v[176:191]
    ds_read_b128 v[236:239], v4 offset:39936
    v_add_f32 v9, v9, v201
    v_add_f32 v8, v8, v202
    v_add_f32 v9, v9, v203
    v_add_f32 v8, v8, v204
    s_waitcnt lgkmcnt(4)
    v_mfma_f32_32x32x16_bf16 v[144:159], v[216:219], v[40:43], v[144:159]
    ds_read_b128 v[208:211], v4 offset:8192
    v_add_f32 v9, v9, v205
    v_add_f32 v8, v8, v206
    v_add_f32 v9, v9, v207
    v_mov_b32 v11, v8
    v_mfma_f32_32x32x16_bf16 v[160:175], v[220:223], v[40:43], v[160:175]
    ds_read_b128 v[212:215], v4 offset:24576
    buffer_load_dwordx4 v[88:91], v2, s[40:43], s54 offen offset:2048 sc1
    v_mov_b32 v12, v9
    s_nop 1
    v_permlane32_swap_b32 v8, v11
    s_waitcnt lgkmcnt(4)
    v_mfma_f32_32x32x16_bf16 v[176:191], v[224:227], v[40:43], v[176:191]
    ds_read_b128 v[216:219], v4 offset:40960
    v_permlane32_swap_b32 v9, v12
    s_nop 0
    v_add_f32 v8, v8, v11
    v_add_f32 v9, v9, v12
    v_mfma_f32_32x32x16_bf16 v[144:159], v[228:231], v[44:47], v[144:159]
    ds_read_b128 v[220:223], v4 offset:9216
    v_mul_f32 v8, 0xbb000000, v8
    v_mul_f32 v9, 0x3b000000, v9
    v_fma_f32 v9, -v8, v8, v9
    v_max_f32 v9, 0, v9
    s_waitcnt lgkmcnt(4)
    v_mfma_f32_32x32x16_bf16 v[160:175], v[232:235], v[44:47], v[160:175]
    ds_read_b128 v[224:227], v4 offset:25600
    buffer_load_dwordx4 v[92:95], v2, s[40:43], s54 offen offset:3072 sc1
    v_add_f32 v14, 0x3727c5ac, v9
    v_rsq_f32 v9, v14
    v_cvt_pk_bf16_f32 v252, v8, v8
    v_mfma_f32_32x32x16_bf16 v[176:191], v[236:239], v[44:47], v[176:191]
    ds_read_b128 v[228:231], v4 offset:41984
    v_mul_f32 v10, 0xc0135761, v9
    v_mul_f32 v12, v9, v9
    v_and_b32 v11, 0xffff0000, v252
    v_mul_f32 v12, v12, v9
    s_waitcnt vmcnt(8)
    v_max3_u32 v7, v48, v49, v50
    v_max3_u32 v7, v7, v51, v52
    v_max3_u32 v7, v7, v53, v54
    v_max3_u32 v7, v7, v55, v56
    v_max3_u32 v7, v7, v57, v58
    v_max3_u32 v7, v7, v59, v60
    v_max3_u32 v7, v7, v61, v62
    v_max_u32 v7, v7, v63
    v_cmp_eq_u32 vcc, -1, v7
    s_nop 1
    s_cbranch_vccnz L_rt_45
L_bk_46:
    s_waitcnt lgkmcnt(4)
    v_mfma_f32_32x32x16_bf16 v[144:159], v[208:211], v[48:51], v[144:159]
    ds_read_b128 v[232:235], v4 offset:10240
    v_sub_f32 v11, v8, v11
    v_mul_f32 v12, 0xbdd2d3e8, v12
    v_cvt_pk_bf16_f32 v253, v11, v11
    v_cmp_gt_u32 s[52:53], 32, v1
    v_mfma_f32_32x32x16_bf16 v[160:175], v[212:215], v[48:51], v[160:175]
    ds_read_b128 v[236:239], v4 offset:26624
    s_add_u32 s54, s78, 20480
    buffer_load_dwordx4 v[96:99], v2, s[40:43], s54 offen offset:0 sc1
    v_and_b32 v253, 0xffff, v253
    v_mov_b32 v254, 0
    v_mov_b32 v255, 0
    s_waitcnt lgkmcnt(4)
    v_mfma_f32_32x32x16_bf16 v[176:191], v[216:219], v[48:51], v[176:191]
    ds_read_b128 v[208:211], v4 offset:43008
    v_cndmask_b32 v252, 0, v252, s[52:53]
    v_cndmask_b32 v253, 0, v253, s[52:53]
    v_mfma_f32_32x32x16_bf16 v[144:159], v[220:223], v[52:55], v[144:159]
    ds_read_b128 v[212:215], v4 offset:11264
    s_waitcnt lgkmcnt(4)
    v_mfma_f32_32x32x16_bf16 v[160:175], v[224:227], v[52:55], v[160:175]
    ds_read_b128 v[216:219], v4 offset:27648
    buffer_load_dwordx4 v[100:103], v2, s[40:43], s54 offen offset:1024 sc1
    v_mfma_f32_32x32x16_bf16 v[176:191], v[228:231], v[52:55], v[176:191]
    ds_read_b128 v[220:223], v4 offset:44032
    s_waitcnt lgkmcnt(4)
    v_mfma_f32_32x32x16_bf16 v[144:159], v[232:235], v[56:59], v[144:159]
    ds_read_b128 v[224:227], v4 offset:12288
    v_mfma_f32_32x32x16_bf16 v[160:175], v[236:239], v[56:59], v[160:175]
    ds_read_b128 v[228:231], v4 offset:28672
    buffer_load_dwordx4 v[104:107], v2, s[40:43], s54 offen offset:2048 sc1
    s_waitcnt lgkmcnt(4)
    v_mfma_f32_32x32x16_bf16 v[176:191], v[208:211], v[56:59], v[176:191]
    ds_read_b128 v[232:235], v4 offset:45056
    v_mfma_f32_32x32x16_bf16 v[144:159], v[212:215], v[60:63], v[144:159]
    ds_read_b128 v[236:239], v4 offset:13312
    s_waitcnt lgkmcnt(4)
    v_mfma_f32_32x32x16_bf16 v[160:175], v[216:219], v[60:63], v[160:175]
    ds_read_b128 v[208:211], v4 offset:29696
    buffer_load_dwordx4 v[108:111], v2, s[40:43], s54 offen offset:3072 sc1
    v_mfma_f32_32x32x16_bf16 v[176:191], v[220:223], v[60:63], v[176:191]
    ds_read_b128 v[212:215], v4 offset:46080
    s_waitcnt vmcnt(8)
    v_max3_u32 v7, v64, v65, v66
    v_max3_u32 v7, v7, v67, v68
    v_max3_u32 v7, v7, v69, v70
    v_max3_u32 v7, v7, v71, v72
    v_max3_u32 v7, v7, v73, v74
    v_max3_u32 v7, v7, v75, v76
    v_max3_u32 v7, v7, v77, v78
    v_max_u32 v7, v7, v79
    v_cmp_eq_u32 vcc, -1, v7
    s_nop 1
    s_cbranch_vccnz L_rt_48
L_bk_49:
    s_waitcnt lgkmcnt(4)
    v_mfma_f32_32x32x16_bf16 v[144:159], v[224:227], v[64:67], v[144:159]
    ds_read_b128 v[216:219], v4 offset:14336
    v_mfma_f32_32x32x16_bf16 v[160:175], v[228:231], v[64:67], v[160:175]
    ds_read_b128 v[220:223], v4 offset:30720
    s_add_u32 s54, s78, 24576
    buffer_load_dwordx4 v[112:115], v2, s[40:43], s54 offen offset:0 sc1
    s_waitcnt lgkmcnt(4)
    v_mfma_f32_32x32x16_bf16 v[176:191], v[232:235], v[64:67], v[176:191]
    ds_read_b128 v[224:227], v4 offset:47104
    v_mfma_f32_32x32x16_bf16 v[144:159], v[236:239], v[68:71], v[144:159]
    ds_read_b128 v[228:231], v4 offset:15360
    s_waitcnt lgkmcnt(4)
    v_mfma_f32_32x32x16_bf16 v[160:175], v[208:211], v[68:71], v[160:175]
    ds_read_b128 v[232:235], v4 offset:31744
    buffer_load_dwordx4 v[116:119], v2, s[40:43], s54 offen offset:1024 sc1
    v_mfma_f32_32x32x16_bf16 v[176:191], v[212:215], v[68:71], v[176:191]
    ds_read_b128 v[236:239], v4 offset:48128
    s_waitcnt lgkmcnt(4)
    v_mfma_f32_32x32x16_bf16 v[144:159], v[216:219], v[72:75], v[144:159]
    ds_read_b128 v[208:211], v4 offset:49152
    v_mfma_f32_32x32x16_bf16 v[160:175], v[220:223], v[72:75], v[160:175]
    ds_read_b128 v[212:215], v5 offset:0
    buffer_load_dwordx4 v[120:123], v2, s[40:43], s54 offen offset:2048 sc1
    s_waitcnt lgkmcnt(4)
    v_mfma_f32_32x32x16_bf16 v[176:191], v[224:227], v[72:75], v[176:191]
    ds_read_b128 v[216:219], v5 offset:16384
    v_mfma_f32_32x32x16_bf16 v[144:159], v[228:231], v[76:79], v[144:159]
    ds_read_b128 v[220:223], v4 offset:50176
    s_waitcnt lgkmcnt(4)
    v_mfma_f32_32x32x16_bf16 v[160:175], v[232:235], v[76:79], v[160:175]
    ds_read_b128 v[224:227], v5 offset:1024
    buffer_load_dwordx4 v[124:127], v2, s[40:43], s54 offen offset:3072 sc1
    v_mfma_f32_32x32x16_bf16 v[176:191], v[236:239], v[76:79], v[176:191]
    ds_read_b128 v[228:231], v5 offset:17408
    s_barrier
    s_waitcnt vmcnt(8)
    v_max3_u32 v7, v80, v81, v82
    v_max3_u32 v7, v7, v83, v84
    v_max3_u32 v7, v7, v85, v86
    v_max3_u32 v7, v7, v87, v88
    v_max3_u32 v7, v7, v89, v90
    v_max3_u32 v7, v7, v91, v92
    v_max3_u32 v7, v7, v93, v94
    v_max_u32 v7, v7, v95
    v_cmp_eq_u32 vcc, -1, v7
    s_nop 1
    s_cbranch_vccnz L_rt_51
L_bk_52:
    s_waitcnt lgkmcnt(4)
    v_mfma_f32_32x32x16_bf16 v[144:159], v[208:211], v[80:83], v[144:159]
    ds_read_b128 v[232:235], v4 offset:51200
    v_mfma_f32_32x32x16_bf16 v[160:175], v[212:215], v[80:83], v[160:175]
    ds_read_b128 v[236:239], v5 offset:2048
    s_add_u32 s54, s78, 28672
    buffer_load_dwordx4 v[128:131], v2, s[40:43], s54 offen offset:0 sc1
    s_waitcnt lgkmcnt(4)
    v_mfma_f32_32x32x16_bf16 v[176:191], v[216:219], v[80:83], v[176:191]
    ds_read_b128 v[208:211], v5 offset:18432
    v_mfma_f32_32x32x16_bf16 v[144:159], v[220:223], v[84:87], v[144:159]
    ds_read_b128 v[212:215], v4 offset:52224
    s_waitcnt lgkmcnt(4)
    v_mfma_f32_32x32x16_bf16 v[160:175], v[224:227], v[84:87], v[160:175]
    ds_read_b128 v[216:219], v5 offset:3072
    buffer_load_dwordx4 v[132:135], v2, s[40:43], s54 offen offset:1024 sc1
    v_mfma_f32_32x32x16_bf16 v[176:191], v[228:231], v[84:87], v[176:191]
    ds_read_b128 v[220:223], v5 offset:19456
    s_waitcnt lgkmcnt(4)
    v_mfma_f32_32x32x16_bf16 v[144:159], v[232:235], v[88:91], v[144:159]
    ds_read_b128 v[224:227], v4 offset:53248
    v_mfma_f32_32x32x16_bf16 v[160:175], v[236:239], v[88:91], v[160:175]
    ds_read_b128 v[228:231], v5 offset:4096
    buffer_load_dwordx4 v[136:139], v2, s[40:43], s54 offen offset:2048 sc1
    s_waitcnt lgkmcnt(4)
    v_mfma_f32_32x32x16_bf16 v[176:191], v[208:211], v[88:91], v[176:191]
    ds_read_b128 v[232:235], v5 offset:20480
    v_mfma_f32_32x32x16_bf16 v[144:159], v[212:215], v[92:95], v[144:159]
    ds_read_b128 v[236:239], v4 offset:54272
    s_waitcnt lgkmcnt(4)
    v_mfma_f32_32x32x16_bf16 v[160:175], v[216:219], v[92:95], v[160:175]
    ds_read_b128 v[208:211], v5 offset:5120
    buffer_load_dwordx4 v[140:143], v2, s[40:43], s54 offen offset:3072 sc1
    v_mfma_f32_32x32x16_bf16 v[176:191], v[220:223], v[92:95], v[176:191]
    ds_read_b128 v[212:215], v5 offset:21504
    s_waitcnt vmcnt(8)
    v_max3_u32 v7, v96, v97, v98
    v_max3_u32 v7, v7, v99, v100
    v_max3_u32 v7, v7, v101, v102
    v_max3_u32 v7, v7, v103, v104
    v_max3_u32 v7, v7, v105, v106
    v_max3_u32 v7, v7, v107, v108
    v_max3_u32 v7, v7, v109, v110
    v_max_u32 v7, v7, v111
    v_cmp_eq_u32 vcc, -1, v7
    s_nop 1
    s_cbranch_vccnz L_rt_54
L_bk_55:
    s_waitcnt lgkmcnt(4)
    v_mfma_f32_32x32x16_bf16 v[144:159], v[224:227], v[96:99], v[144:159]
    ds_read_b128 v[216:219], v4 offset:55296
    v_mfma_f32_32x32x16_bf16 v[160:175], v[228:231], v[96:99], v[160:175]
    ds_read_b128 v[220:223], v5 offset:6144
    s_waitcnt lgkmcnt(4)
    v_mfma_f32_32x32x16_bf16 v[176:191], v[232:235], v[96:99], v[176:191]
    ds_read_b128 v[224:227], v5 offset:22528
    v_mfma_f32_32x32x16_bf16 v[144:159], v[236:239], v[100:103], v[144:159]
    ds_read_b128 v[228:231], v4 offset:56320
    s_add_u32 m0, s74, 0
    s_add_u32 s75, s77, 131072
    buffer_load_dwordx4 v2, s[40:43], s75 offen offset:0 sc1 lds
    s_waitcnt lgkmcnt(4)
    v_mfma_f32_32x32x16_bf16 v[160:175], v[208:211], v[100:103], v[160:175]
    ds_read_b128 v[232:235], v5 offset:7168
    buffer_load_dwordx4 v2, s[40:43], s75 offen offset:1024 sc1 lds
    v_mfma_f32_32x32x16_bf16 v[176:191], v[212:215], v[100:103], v[176:191]
    ds_read_b128 v[236:239], v5 offset:23552
    buffer_load_dwordx4 v2, s[40:43], s75 offen offset:2048 sc1 lds
    s_waitcnt lgkmcnt(4)
    v_mfma_f32_32x32x16_bf16 v[144:159], v[216:219], v[104:107], v[144:159]
    ds_read_b128 v[208:211], v4 offset:57344
    buffer_load_dwordx4 v2, s[40:43], s75 offen offset:3072 sc1 lds
    v_mfma_f32_32x32x16_bf16 v[160:175], v[220:223], v[104:107], v[160:175]
    ds_read_b128 v[212:215], v5 offset:8192
    s_add_u32 m0, s74, 16384
    s_add_u32 s75, s77, 163840
    buffer_load_dwordx4 v2, s[40:43], s75 offen offset:0 sc1 lds
    s_waitcnt lgkmcnt(4)
    v_mfma_f32_32x32x16_bf16 v[176:191], v[224:227], v[104:107], v[176:191]
    ds_read_b128 v[216:219], v5 offset:24576
    buffer_load_dwordx4 v2, s[40:43], s75 offen offset:1024 sc1 lds
    v_mfma_f32_32x32x16_bf16 v[144:159], v[228:231], v[108:111], v[144:159]
    ds_read_b128 v[220:223], v4 offset:58368
    buffer_load_dwordx4 v2, s[40:43], s75 offen offset:2048 sc1 lds
    s_waitcnt lgkmcnt(4)
    v_mfma_f32_32x32x16_bf16 v[160:175], v[232:235], v[108:111], v[160:175]
    ds_read_b128 v[224:227], v5 offset:9216
    buffer_load_dwordx4 v2, s[40:43], s75 offen offset:3072 sc1 lds
    v_mfma_f32_32x32x16_bf16 v[176:191], v[236:239], v[108:111], v[176:191]
    ds_read_b128 v[228:231], v5 offset:25600
    s_add_u32 m0, s74, 32768
    s_add_u32 s75, s77, 196608
    buffer_load_dwordx4 v2, s[40:43], s75 offen offset:0 sc1 lds
    s_waitcnt vmcnt(13)
    v_max3_u32 v7, v112, v113, v114
    v_max3_u32 v7, v7, v115, v116
    v_max3_u32 v7, v7, v117, v118
    v_max3_u32 v7, v7, v119, v120
    v_max3_u32 v7, v7, v121, v122
    v_max3_u32 v7, v7, v123, v124
    v_max3_u32 v7, v7, v125, v126
    v_max_u32 v7, v7, v127
    v_cmp_eq_u32 vcc, -1, v7
    s_nop 1
    s_cbranch_vccnz L_rt_57
L_bk_58:
    s_waitcnt lgkmcnt(4)
    v_mfma_f32_32x32x16_bf16 v[144:159], v[208:211], v[112:115], v[144:159]
    ds_read_b128 v[232:235], v4 offset:59392
    buffer_load_dwordx4 v2, s[40:43], s75 offen offset:1024 sc1 lds
    v_mfma_f32_32x32x16_bf16 v[160:175], v[212:215], v[112:115], v[160:175]
    ds_read_b128 v[236:239], v5 offset:10240
    buffer_load_dwordx4 v2, s[40:43], s75 offen offset:2048 sc1 lds
    s_waitcnt lgkmcnt(4)
    v_mfma_f32_32x32x16_bf16 v[176:191], v[216:219], v[112:115], v[176:191]
    ds_read_b128 v[208:211], v5 offset:26624
    buffer_load_dwordx4 v2, s[40:43], s75 offen offset:3072 sc1 lds
    v_mfma_f32_32x32x16_bf16 v[144:159], v[220:223], v[116:119], v[144:159]
    ds_read_b128 v[212:215], v4 offset:60416
    s_waitcnt lgkmcnt(4)
    v_mfma_f32_32x32x16_bf16 v[160:175], v[224:227], v[116:119], v[160:175]
    ds_read_b128 v[216:219], v5 offset:11264
    v_mfma_f32_32x32x16_bf16 v[176:191], v[228:231], v[116:119], v[176:191]
    ds_read_b128 v[220:223], v5 offset:27648
    s_waitcnt lgkmcnt(4)
    v_mfma_f32_32x32x16_bf16 v[144:159], v[232:235], v[120:123], v[144:159]
    ds_read_b128 v[224:227], v4 offset:61440
    v_mfma_f32_32x32x16_bf16 v[160:175], v[236:239], v[120:123], v[160:175]
    ds_read_b128 v[228:231], v5 offset:12288
    s_waitcnt lgkmcnt(4)
    v_mfma_f32_32x32x16_bf16 v[176:191], v[208:211], v[120:123], v[176:191]
    ds_read_b128 v[232:235], v5 offset:28672
    v_mfma_f32_32x32x16_bf16 v[144:159], v[212:215], v[124:127], v[144:159]
    ds_read_b128 v[236:239], v4 offset:62464
    s_waitcnt lgkmcnt(4)
    v_mfma_f32_32x32x16_bf16 v[160:175], v[216:219], v[124:127], v[160:175]
    ds_read_b128 v[208:211], v5 offset:13312
    v_mfma_f32_32x32x16_bf16 v[176:191], v[220:223], v[124:127], v[176:191]
    ds_read_b128 v[212:215], v5 offset:29696
    s_waitcnt vmcnt(12)
    v_max3_u32 v7, v128, v129, v130
    v_max3_u32 v7, v7, v131, v132
    v_max3_u32 v7, v7, v133, v134
    v_max3_u32 v7, v7, v135, v136
    v_max3_u32 v7, v7, v137, v138
    v_max3_u32 v7, v7, v139, v140
    v_max3_u32 v7, v7, v141, v142
    v_max_u32 v7, v7, v143
    v_cmp_eq_u32 vcc, -1, v7
    s_nop 1
    s_cbranch_vccnz L_rt_60
L_bk_61:
    s_waitcnt lgkmcnt(4)
    v_mfma_f32_32x32x16_bf16 v[144:159], v[224:227], v[128:131], v[144:159]
    ds_read_b128 v[216:219], v4 offset:63488
    v_mfma_f32_32x32x16_bf16 v[160:175], v[228:231], v[128:131], v[160:175]
    ds_read_b128 v[220:223], v5 offset:14336
    s_waitcnt lgkmcnt(4)
    v_mfma_f32_32x32x16_bf16 v[176:191], v[232:235], v[128:131], v[176:191]
    ds_read_b128 v[224:227], v5 offset:30720
    v_mfma_f32_32x32x16_bf16 v[144:159], v[236:239], v[132:135], v[144:159]
    ds_read_b128 v[228:231], v4 offset:64512
    s_waitcnt lgkmcnt(4)
    v_mfma_f32_32x32x16_bf16 v[160:175], v[208:211], v[132:135], v[160:175]
    ds_read_b128 v[232:235], v5 offset:15360
    v_mfma_f32_32x32x16_bf16 v[176:191], v[212:215], v[132:135], v[176:191]
    ds_read_b128 v[236:239], v5 offset:31744
    s_waitcnt lgkmcnt(4)
    v_mfma_f32_32x32x16_bf16 v[144:159], v[216:219], v[136:139], v[144:159]
    ds_read_b128 v[208:211], v6 offset:0
    v_mfma_f32_32x32x16_bf16 v[160:175], v[220:223], v[136:139], v[160:175]
    ds_read_b128 v[212:215], v6 offset:1024
    s_waitcnt lgkmcnt(4)
    v_mfma_f32_32x32x16_bf16 v[176:191], v[224:227], v[136:139], v[176:191]
    ds_read_b128 v[216:219], v6 offset:2048
    v_mfma_f32_32x32x16_bf16 v[144:159], v[228:231], v[140:143], v[144:159]
    ds_read_b128 v[220:223], v5 offset:32768
    s_waitcnt lgkmcnt(4)
    v_mfma_f32_32x32x16_bf16 v[160:175], v[232:235], v[140:143], v[160:175]
    ds_read_b128 v[224:227], v5 offset:33792
    v_mfma_f32_32x32x16_bf16 v[176:191], v[236:239], v[140:143], v[176:191]
    ds_read_b128 v[228:231], v5 offset:34816
    s_waitcnt lgkmcnt(4)
    v_mfma_f32_32x32x16_bf16 v[144:159], v[208:211], v[252:255], v[144:159]
    ds_read_b128 v[232:235], v5 offset:35840
    v_mfma_f32_32x32x16_bf16 v[160:175], v[212:215], v[252:255], v[160:175]
    ds_read_b128 v[236:239], v5 offset:36864
    s_waitcnt lgkmcnt(4)
    v_mfma_f32_32x32x16_bf16 v[176:191], v[216:219], v[252:255], v[176:191]
    ds_read_b128 v[208:211], v5 offset:37888
    s_barrier
    v_mfma_f32_32x32x16_bf16 v[192:207], v[220:223], v[16:19], 0
    ds_read_b128 v[212:215], v5 offset:38912
    s_add_u32 m0, s74, 49152
    s_add_u32 s75, s77, 147456
    buffer_load_dwordx4 v2, s[40:43], s75 offen offset:0 sc1 lds
    v_mul_f32 v240, v144, v144
    v_mul_f32 v241, v145, v145
    v_mul_f32 v242, v146, v146
    s_waitcnt lgkmcnt(4)
    v_mfma_f32_32x32x16_bf16 v[192:207], v[224:227], v[20:23], v[192:207]
    ds_read_b128 v[216:219], v5 offset:39936
    buffer_load_dwordx4 v2, s[40:43], s75 offen offset:1024 sc1 lds
    v_mul_f32 v243, v147, v147
    v_mul_f32 v244, v148, v148
    v_mul_f32 v245, v149, v149
    v_mfma_f32_32x32x16_bf16 v[192:207], v[228:231], v[24:27], v[192:207]
    ds_read_b128 v[220:223], v5 offset:40960
    buffer_load_dwordx4 v2, s[40:43], s75 offen offset:2048 sc1 lds
    v_mul_f32 v246, v150, v150
    v_mul_f32 v247, v151, v151
    v_fma_f32 v240, v240, v12, v10
    s_waitcnt lgkmcnt(4)
    v_mfma_f32_32x32x16_bf16 v[192:207], v[232:235], v[28:31], v[192:207]
    ds_read_b128 v[224:227], v5 offset:41984
    buffer_load_dwordx4 v2, s[40:43], s75 offen offset:3072 sc1 lds
    v_fma_f32 v241, v241, v12, v10
    v_fma_f32 v242, v242, v12, v10
    v_fma_f32 v243, v243, v12, v10
    v_mfma_f32_32x32x16_bf16 v[192:207], v[236:239], v[32:35], v[192:207]
    ds_read_b128 v[228:231], v5 offset:43008
    s_add_u32 m0, s74, 65536
    s_add_u32 s75, s77, 180224
    buffer_load_dwordx4 v2, s[40:43], s75 offen offset:0 sc1 lds
    v_fma_f32 v244, v244, v12, v10
    v_fma_f32 v245, v245, v12, v10
    v_fma_f32 v246, v246, v12, v10
    s_waitcnt lgkmcnt(4)
    v_mfma_f32_32x32x16_bf16 v[192:207], v[208:211], v[36:39], v[192:207]
    ds_read_b128 v[232:235], v5 offset:44032
    buffer_load_dwordx4 v2, s[40:43], s75 offen offset:1024 sc1 lds
    v_fma_f32 v247, v247, v12, v10
    v_mul_f32 v240, v240, v144
    v_mul_f32 v241, v241, v145
    v_mfma_f32_32x32x16_bf16 v[192:207], v[212:215], v[40:43], v[192:207]
    ds_read_b128 v[236:239], v5 offset:45056
    buffer_load_dwordx4 v2, s[40:43], s75 offen offset:2048 sc1 lds
    v_mul_f32 v242, v242, v146
    v_mul_f32 v243, v243, v147
    v_mul_f32 v244, v244, v148
    s_waitcnt lgkmcnt(4)
    v_mfma_f32_32x32x16_bf16 v[192:207], v[216:219], v[44:47], v[192:207]
    ds_read_b128 v[208:211], v5 offset:46080
    buffer_load_dwordx4 v2, s[40:43], s75 offen offset:3072 sc1 lds
    v_mul_f32 v245, v245, v149
    v_mul_f32 v246, v246, v150
    v_mul_f32 v247, v247, v151
    v_mfma_f32_32x32x16_bf16 v[192:207], v[220:223], v[48:51], v[192:207]
    ds_read_b128 v[212:215], v5 offset:47104
    s_add_u32 m0, s74, 81920
    s_add_u32 s75, s77, 212992
    buffer_load_dwordx4 v2, s[40:43], s75 offen offset:0 sc1 lds
    v_exp_f32 v240, v240
    v_mul_f32 v152, v152, v144
    s_waitcnt lgkmcnt(4)
    v_mfma_f32_32x32x16_bf16 v[192:207], v[224:227], v[52:55], v[192:207]
    ds_read_b128 v[216:219], v5 offset:48128
    buffer_load_dwordx4 v2, s[40:43], s75 offen offset:1024 sc1 lds
    v_exp_f32 v241, v241
    v_mul_f32 v153, v153, v145
    v_mfma_f32_32x32x16_bf16 v[192:207], v[228:231], v[56:59], v[192:207]
    ds_read_b128 v[220:223], v5 offset:49152
    buffer_load_dwordx4 v2, s[40:43], s75 offen offset:2048 sc1 lds
    v_exp_f32 v242, v242
    v_mul_f32 v154, v154, v146
    s_waitcnt lgkmcnt(4)
    v_mfma_f32_32x32x16_bf16 v[192:207], v[232:235], v[60:63], v[192:207]
    ds_read_b128 v[224:227], v5 offset:50176
    buffer_load_dwordx4 v2, s[40:43], s75 offen offset:3072 sc1 lds
    v_exp_f32 v243, v243
    v_mul_f32 v155, v155, v147
    v_mfma_f32_32x32x16_bf16 v[192:207], v[236:239], v[64:67], v[192:207]
    ds_read_b128 v[228:231], v5 offset:51200
    v_exp_f32 v244, v244
    v_mul_f32 v156, v156, v148
    s_waitcnt lgkmcnt(4)
    v_mfma_f32_32x32x16_bf16 v[192:207], v[208:211], v[68:71], v[192:207]
    ds_read_b128 v[232:235], v5 offset:52224
    s_cmp_eq_u32 s67, 0
    s_cselect_b64 vcc, -1, 0
    s_nop 1
    s_cbranch_vccz L_wd_63
    s_add_u32 s24, s16, 0
    s_add_u32 s25, s17, 0
    buffer_load_dwordx4 a[0:3], v2, s[40:43], s24 offen offset:0 sc1
    buffer_load_dwordx4 a[4:7], v2, s[40:43], s25 offen offset:0 sc1
L_wd_63:
    v_exp_f32 v245, v245
    v_mul_f32 v157, v157, v149
    v_mfma_f32_32x32x16_bf16 v[192:207], v[212:215], v[72:75], v[192:207]
    ds_read_b128 v[236:239], v5 offset:53248
    v_exp_f32 v246, v246
    v_mul_f32 v158, v158, v150
    s_waitcnt lgkmcnt(4)
    v_mfma_f32_32x32x16_bf16 v[192:207], v[216:219], v[76:79], v[192:207]
    ds_read_b128 v[208:211], v5 offset:54272
    v_exp_f32 v247, v247
    v_mul_f32 v159, v159, v151
    v_fma_f32 v240, v240, v14, v14
    v_mfma_f32_32x32x16_bf16 v[192:207], v[220:223], v[80:83], v[192:207]
    ds_read_b128 v[212:215], v5 offset:55296
    v_fma_f32 v241, v241, v14, v14
    v_fma_f32 v242, v242, v14, v14
    v_fma_f32 v243, v243, v14, v14
    v_fma_f32 v244, v244, v14, v14
    s_waitcnt lgkmcnt(4)
    v_mfma_f32_32x32x16_bf16 v[192:207], v[224:227], v[84:87], v[192:207]
    ds_read_b128 v[216:219], v5 offset:56320
    s_cbranch_vccz L_wd_64
    buffer_load_dwordx4 a[8:11], v2, s[40:43], s24 offen offset:1024 sc1
    buffer_load_dwordx4 a[12:15], v2, s[40:43], s25 offen offset:1024 sc1
L_wd_64:
    v_fma_f32 v245, v245, v14, v14
    v_fma_f32 v246, v246, v14, v14
    v_fma_f32 v247, v247, v14, v14
    v_mfma_f32_32x32x16_bf16 v[192:207], v[228:231], v[88:91], v[192:207]
    ds_read_b128 v[220:223], v5 offset:57344
    v_rcp_f32 v240, v240
    v_rcp_f32 v241, v241
    s_waitcnt lgkmcnt(4)
    v_mfma_f32_32x32x16_bf16 v[192:207], v[232:235], v[92:95], v[192:207]
    ds_read_b128 v[224:227], v5 offset:58368
    v_rcp_f32 v242, v242
    v_rcp_f32 v243, v243
    v_mfma_f32_32x32x16_bf16 v[192:207], v[236:239], v[96:99], v[192:207]
    ds_read_b128 v[228:231], v5 offset:59392
    v_rcp_f32 v244, v244
    v_rcp_f32 v245, v245
    s_waitcnt lgkmcnt(4)
    v_mfma_f32_32x32x16_bf16 v[192:207], v[208:211], v[100:103], v[192:207]
    ds_read_b128 v[232:235], v5 offset:60416
    s_cbranch_vccz L_wd_65
    buffer_load_dwordx4 a[16:19], v2, s[40:43], s24 offen offset:2048 sc1
    buffer_load_dwordx4 a[20:23], v2, s[40:43], s25 offen offset:2048 sc1
L_wd_65:
    v_rcp_f32 v246, v246
    v_mfma_f32_32x32x16_bf16 v[192:207], v[212:215], v[104:107], v[192:207]
    ds_read_b128 v[236:239], v5 offset:61440
    v_rcp_f32 v247, v247
    s_nop 0
    v_mul_f32 v152, v152, v240
    s_waitcnt lgkmcnt(4)
    v_mfma_f32_32x32x16_bf16 v[192:207], v[216:219], v[108:111], v[192:207]
    ds_read_b128 v[208:211], v5 offset:62464
    v_mul_f32 v153, v153, v241
    v_mul_f32 v154, v154, v242
    v_mul_f32 v155, v155, v243
    v_mul_f32 v156, v156, v244
    v_mfma_f32_32x32x16_bf16 v[192:207], v[220:223], v[112:115], v[192:207]
    ds_read_b128 v[212:215], v5 offset:63488
    v_mul_f32 v157, v157, v245
    v_mul_f32 v158, v158, v246
    v_mul_f32 v159, v159, v247
    v_cvt_pk_bf16_f32 v248, v152, v153
    s_cmp_lg_u32 s67, 0
    s_cbranch_scc1 L_vl_66
    s_waitcnt vmcnt(18)
    s_branch L_vl_67
L_vl_66:
    s_waitcnt vmcnt(12)
L_vl_67:
    s_barrier
    s_waitcnt lgkmcnt(4)
    v_mfma_f32_32x32x16_bf16 v[192:207], v[224:227], v[116:119], v[192:207]
    ds_read_b128 v[216:219], v5 offset:64512
    s_cbranch_vccz L_wd_68
    buffer_load_dwordx4 a[24:27], v2, s[40:43], s24 offen offset:3072 sc1
    buffer_load_dwordx4 a[28:31], v2, s[40:43], s25 offen offset:3072 sc1
L_wd_68:
    v_cvt_pk_bf16_f32 v249, v154, v155
    v_cvt_pk_bf16_f32 v250, v156, v157
    v_cvt_pk_bf16_f32 v251, v158, v159
    v_mfma_f32_32x32x16_bf16 v[192:207], v[228:231], v[120:123], v[192:207]
    ds_read_b128 v[220:223], v6 offset:3072
    s_add_u32 s55, s76, 0
    buffer_store_dwordx4 v[248:251], v2, s[40:43], s55 offen sc1
    s_waitcnt lgkmcnt(4)
    v_mfma_f32_32x32x16_bf16 v[192:207], v[232:235], v[124:127], v[192:207]
    ds_read_b128 v[224:227], v4 offset:0
    v_mul_f32 v240, v160, v160
    v_mul_f32 v241, v161, v161
    v_mul_f32 v242, v162, v162
    v_mul_f32 v243, v163, v163
    v_mfma_f32_32x32x16_bf16 v[192:207], v[236:239], v[128:131], v[192:207]
    ds_read_b128 v[228:231], v4 offset:1024
    v_mul_f32 v244, v164, v164
    v_mul_f32 v245, v165, v165
    v_mul_f32 v246, v166, v166
    v_mul_f32 v247, v167, v167
    s_waitcnt lgkmcnt(4)
    v_mfma_f32_32x32x16_bf16 v[192:207], v[208:211], v[132:135], v[192:207]
    ds_read_b128 v[232:235], v4 offset:2048
    s_cbranch_vccz L_wd_69
    s_add_u32 s24, s16, 4096
    s_add_u32 s25, s17, 4096
    buffer_load_dwordx4 a[32:35], v2, s[40:43], s24 offen offset:0 sc1
    buffer_load_dwordx4 a[36:39], v2, s[40:43], s25 offen offset:0 sc1
L_wd_69:
    v_fma_f32 v240, v240, v12, v10
    v_fma_f32 v241, v241, v12, v10
    v_fma_f32 v242, v242, v12, v10
    v_mfma_f32_32x32x16_bf16 v[192:207], v[212:215], v[136:139], v[192:207]
    ds_read_b128 v[236:239], v4 offset:3072
    v_fma_f32 v243, v243, v12, v10
    v_fma_f32 v244, v244, v12, v10
    v_fma_f32 v245, v245, v12, v10
    v_fma_f32 v246, v246, v12, v10
    s_waitcnt lgkmcnt(4)
    v_mfma_f32_32x32x16_bf16 v[192:207], v[216:219], v[140:143], v[192:207]
    ds_read_b128 v[208:211], v4 offset:4096
    v_fma_f32 v247, v247, v12, v10
    v_mul_f32 v240, v240, v160
    v_mul_f32 v241, v241, v161
    v_mul_f32 v242, v242, v162
    v_mfma_f32_32x32x16_bf16 v[192:207], v[220:223], v[252:255], v[192:207]
    ds_read_b128 v[212:215], v4 offset:5120
    v_mul_f32 v243, v243, v163
    v_mul_f32 v244, v244, v164
    v_mul_f32 v245, v245, v165
    v_mul_f32 v246, v246, v166
    s_waitcnt lgkmcnt(4)
    v_mfma_f32_32x32x16_bf16 v[144:159], v[224:227], v[16:19], 0
    ds_read_b128 v[216:219], v4 offset:6144
    s_cbranch_vccz L_wd_70
    buffer_load_dwordx4 a[40:43], v2, s[40:43], s24 offen offset:1024 sc1
    buffer_load_dwordx4 a[44:47], v2, s[40:43], s25 offen offset:1024 sc1
L_wd_70:
    v_mul_f32 v247, v247, v167
    v_exp_f32 v240, v240
    v_mfma_f32_32x32x16_bf16 v[144:159], v[228:231], v[20:23], v[144:159]
    ds_read_b128 v[220:223], v4 offset:7168
    v_mul_f32 v168, v168, v160
    v_exp_f32 v241, v241
    v_mul_f32 v169, v169, v161
    s_waitcnt lgkmcnt(4)
    v_mfma_f32_32x32x16_bf16 v[144:159], v[232:235], v[24:27], v[144:159]
    ds_read_b128 v[224:227], v4 offset:8192
    v_exp_f32 v242, v242
    v_mul_f32 v170, v170, v162
    v_mfma_f32_32x32x16_bf16 v[144:159], v[236:239], v[28:31], v[144:159]
    ds_read_b128 v[228:231], v4 offset:9216
    v_exp_f32 v243, v243
    v_mul_f32 v171, v171, v163
    s_waitcnt lgkmcnt(4)
    v_mfma_f32_32x32x16_bf16 v[144:159], v[208:211], v[32:35], v[144:159]
    ds_read_b128 v[232:235], v4 offset:10240
    s_cbranch_vccz L_wd_71
    buffer_load_dwordx4 a[48:51], v2, s[40:43], s24 offen offset:2048 sc1
    buffer_load_dwordx4 a[52:55], v2, s[40:43], s25 offen offset:2048 sc1
L_wd_71:
    v_exp_f32 v244, v244
    v_mul_f32 v172, v172, v164
    v_mfma_f32_32x32x16_bf16 v[144:159], v[212:215], v[36:39], v[144:159]
    ds_read_b128 v[236:239], v4 offset:11264
    v_exp_f32 v245, v245
    v_mul_f32 v173, v173, v165
    s_waitcnt lgkmcnt(4)
    v_mfma_f32_32x32x16_bf16 v[144:159], v[216:219], v[40:43], v[144:159]
    ds_read_b128 v[208:211], v4 offset:12288
    v_exp_f32 v246, v246
    v_mul_f32 v174, v174, v166
    v_mfma_f32_32x32x16_bf16 v[144:159], v[220:223], v[44:47], v[144:159]
    ds_read_b128 v[212:215], v4 offset:13312
    v_exp_f32 v247, v247
    v_mul_f32 v175, v175, v167
    v_fma_f32 v240, v240, v14, v14
    s_cmp_lg_u32 s67, 0
    s_cbranch_scc1 L_vl_72
    s_waitcnt vmcnt(15)
    s_branch L_vl_73
L_vl_72:
    s_waitcnt vmcnt(1)
L_vl_73:
    s_barrier
    s_waitcnt lgkmcnt(4)
    v_mfma_f32_32x32x16_bf16 v[144:159], v[224:227], v[48:51], v[144:159]
    ds_read_b128 v[216:219], v4 offset:14336
    s_cbranch_vccz L_wd_74
    buffer_load_dwordx4 a[56:59], v2, s[40:43], s24 offen offset:3072 sc1
    buffer_load_dwordx4 a[60:63], v2, s[40:43], s25 offen offset:3072 sc1
L_wd_74:
    v_fma_f32 v241, v241, v14, v14
    v_fma_f32 v242, v242, v14, v14
    v_fma_f32 v243, v243, v14, v14
    v_mfma_f32_32x32x16_bf16 v[144:159], v[228:231], v[52:55], v[144:159]
    ds_read_b128 v[220:223], v4 offset:15360
    v_fma_f32 v244, v244, v14, v14
    v_fma_f32 v245, v245, v14, v14
    v_fma_f32 v246, v246, v14, v14
    v_fma_f32 v247, v247, v14, v14
    s_waitcnt lgkmcnt(4)
    v_mfma_f32_32x32x16_bf16 v[144:159], v[232:235], v[56:59], v[144:159]
    ds_read_b128 v[224:227], v4 offset:49152
    v_rcp_f32 v240, v240
    v_rcp_f32 v241, v241
    v_mfma_f32_32x32x16_bf16 v[144:159], v[236:239], v[60:63], v[144:159]
    ds_read_b128 v[228:231], v4 offset:50176
    v_rcp_f32 v242, v242
    v_rcp_f32 v243, v243
    s_waitcnt lgkmcnt(4)
    v_mfma_f32_32x32x16_bf16 v[144:159], v[208:211], v[64:67], v[144:159]
    ds_read_b128 v[232:235], v4 offset:51200
    s_cbranch_vccz L_wd_75
    s_add_u32 s24, s16, 8192
    s_add_u32 s25, s17, 8192
    buffer_load_dwordx4 a[64:67], v2, s[40:43], s24 offen offset:0 sc1
    buffer_load_dwordx4 a[68:71], v2, s[40:43], s25 offen offset:0 sc1
L_wd_75:
    v_rcp_f32 v244, v244
    v_mfma_f32_32x32x16_bf16 v[144:159], v[212:215], v[68:71], v[144:159]
    ds_read_b128 v[236:239], v4 offset:52224
    v_rcp_f32 v245, v245
    v_rcp_f32 v246, v246
    s_waitcnt lgkmcnt(4)
    v_mfma_f32_32x32x16_bf16 v[144:159], v[216:219], v[72:75], v[144:159]
    ds_read_b128 v[208:211], v4 offset:53248
    v_rcp_f32 v247, v247
    s_nop 0
    v_mul_f32 v168, v168, v240
    v_mfma_f32_32x32x16_bf16 v[144:159], v[220:223], v[76:79], v[144:159]
    ds_read_b128 v[212:215], v4 offset:54272
    v_mul_f32 v169, v169, v241
    v_mul_f32 v170, v170, v242
    v_mul_f32 v171, v171, v243
    v_mul_f32 v172, v172, v244
    s_waitcnt lgkmcnt(4)
    v_mfma_f32_32x32x16_bf16 v[144:159], v[224:227], v[80:83], v[144:159]
    ds_read_b128 v[216:219], v4 offset:55296
    s_cbranch_vccz L_wd_76
    buffer_load_dwordx4 a[72:75], v2, s[40:43], s24 offen offset:1024 sc1
    buffer_load_dwordx4 a[76:79], v2, s[40:43], s25 offen offset:1024 sc1
L_wd_76:
    v_mul_f32 v173, v173, v245
    v_mul_f32 v174, v174, v246
    v_mul_f32 v175, v175, v247
    v_mfma_f32_32x32x16_bf16 v[144:159], v[228:231], v[84:87], v[144:159]
    ds_read_b128 v[220:223], v4 offset:56320
    v_cvt_pk_bf16_f32 v248, v168, v169
    v_cvt_pk_bf16_f32 v249, v170, v171
    v_cvt_pk_bf16_f32 v250, v172, v173
    v_cvt_pk_bf16_f32 v251, v174, v175
    s_waitcnt lgkmcnt(4)
    v_mfma_f32_32x32x16_bf16 v[144:159], v[232:235], v[88:91], v[144:159]
    ds_read_b128 v[224:227], v4 offset:57344
    s_add_u32 s55, s76, 1024
    buffer_store_dwordx4 v[248:251], v2, s[40:43], s55 offen sc1
    v_mfma_f32_32x32x16_bf16 v[144:159], v[236:239], v[92:95], v[144:159]
    ds_read_b128 v[228:231], v4 offset:58368
    v_mul_f32 v240, v176, v176
    v_mul_f32 v241, v177, v177
    v_mul_f32 v242, v178, v178
    v_mul_f32 v243, v179, v179
    s_waitcnt lgkmcnt(4)
    v_mfma_f32_32x32x16_bf16 v[144:159], v[208:211], v[96:99], v[144:159]
    ds_read_b128 v[232:235], v4 offset:59392
    s_cbranch_vccz L_wd_77
    buffer_load_dwordx4 a[80:83], v2, s[40:43], s24 offen offset:2048 sc1
    buffer_load_dwordx4 a[84:87], v2, s[40:43], s25 offen offset:2048 sc1
L_wd_77:
    v_mul_f32 v244, v180, v180
    v_mul_f32 v245, v181, v181
    v_mul_f32 v246, v182, v182
    v_mfma_f32_32x32x16_bf16 v[144:159], v[212:215], v[100:103], v[144:159]
    ds_read_b128 v[236:239], v4 offset:60416
    v_mul_f32 v247, v183, v183
    v_fma_f32 v240, v240, v12, v10
    v_fma_f32 v241, v241, v12, v10
    v_fma_f32 v242, v242, v12, v10
    s_waitcnt lgkmcnt(4)
    v_mfma_f32_32x32x16_bf16 v[144:159], v[216:219], v[104:107], v[144:159]
    ds_read_b128 v[208:211], v4 offset:61440
    v_fma_f32 v243, v243, v12, v10
    v_fma_f32 v244, v244, v12, v10
    v_fma_f32 v245, v245, v12, v10
    v_fma_f32 v246, v246, v12, v10
    v_mfma_f32_32x32x16_bf16 v[144:159], v[220:223], v[108:111], v[144:159]
    ds_read_b128 v[212:215], v4 offset:62464
    v_fma_f32 v247, v247, v12, v10
    v_mul_f32 v240, v240, v176
    v_mul_f32 v241, v241, v177
    v_mul_f32 v242, v242, v178
    s_waitcnt lgkmcnt(4)
    v_mfma_f32_32x32x16_bf16 v[144:159], v[224:227], v[112:115], v[144:159]
    ds_read_b128 v[216:219], v4 offset:63488
    s_cbranch_vccz L_wd_78
    buffer_load_dwordx4 a[88:91], v2, s[40:43], s24 offen offset:3072 sc1
    buffer_load_dwordx4 a[92:95], v2, s[40:43], s25 offen offset:3072 sc1
L_wd_78:
    v_mul_f32 v243, v243, v179
    v_mul_f32 v244, v244, v180
    v_mul_f32 v245, v245, v181
    v_mfma_f32_32x32x16_bf16 v[144:159], v[228:231], v[116:119], v[144:159]
    ds_read_b128 v[220:223], v4 offset:64512
    v_mul_f32 v246, v246, v182
    v_mul_f32 v247, v247, v183
    v_exp_f32 v240, v240
    s_waitcnt lgkmcnt(4)
    v_mfma_f32_32x32x16_bf16 v[144:159], v[232:235], v[120:123], v[144:159]
    ds_read_b128 v[224:227], v6 offset:4096
    v_mul_f32 v184, v184, v176
    v_exp_f32 v241, v241
    v_mul_f32 v185, v185, v177
    v_mfma_f32_32x32x16_bf16 v[144:159], v[236:239], v[124:127], v[144:159]
    ds_read_b128 v[228:231], v4 offset:16384
    v_exp_f32 v242, v242
    v_mul_f32 v186, v186, v178
    s_waitcnt lgkmcnt(4)
    v_mfma_f32_32x32x16_bf16 v[144:159], v[208:211], v[128:131], v[144:159]
    ds_read_b128 v[232:235], v4 offset:17408
    s_cbranch_vccz L_wd_79
    s_add_u32 s24, s16, 12288
    s_add_u32 s25, s17, 12288
    buffer_load_dwordx4 a[96:99], v2, s[40:43], s24 offen offset:0 sc1
    buffer_load_dwordx4 a[100:103], v2, s[40:43], s25 offen offset:0 sc1
L_wd_79:
    v_exp_f32 v243, v243
    v_mul_f32 v187, v187, v179
    v_mfma_f32_32x32x16_bf16 v[144:159], v[212:215], v[132:135], v[144:159]
    ds_read_b128 v[236:239], v4 offset:18432
    v_exp_f32 v244, v244
    v_mul_f32 v188, v188, v180
    s_waitcnt lgkmcnt(4)
    v_mfma_f32_32x32x16_bf16 v[144:159], v[216:219], v[136:139], v[144:159]
    ds_read_b128 v[208:211], v4 offset:19456
    v_exp_f32 v245, v245
    v_mul_f32 v189, v189, v181
    v_mfma_f32_32x32x16_bf16 v[144:159], v[220:223], v[140:143], v[144:159]
    ds_read_b128 v[212:215], v4 offset:20480
    v_exp_f32 v246, v246
    v_mul_f32 v190, v190, v182
    s_waitcnt lgkmcnt(4)
    v_mfma_f32_32x32x16_bf16 v[144:159], v[224:227], v[252:255], v[144:159]
    ds_read_b128 v[216:219], v4 offset:21504
    s_cbranch_vccz L_wd_80
    buffer_load_dwordx4 a[104:107], v2, s[40:43], s24 offen offset:1024 sc1
    buffer_load_dwordx4 a[108:111], v2, s[40:43], s25 offen offset:1024 sc1
L_wd_80:
    v_exp_f32 v247, v247
    v_mul_f32 v191, v191, v183
    v_mfma_f32_32x32x16_bf16 v[160:175], v[228:231], v[16:19], 0
    ds_read_b128 v[220:223], v4 offset:22528
    v_fma_f32 v240, v240, v14, v14
    v_fma_f32 v241, v241, v14, v14
    v_fma_f32 v242, v242, v14, v14
    v_fma_f32 v243, v243, v14, v14
    s_waitcnt lgkmcnt(4)
    v_mfma_f32_32x32x16_bf16 v[160:175], v[232:235], v[20:23], v[160:175]
    ds_read_b128 v[224:227], v4 offset:23552
    v_fma_f32 v244, v244, v14, v14
    v_fma_f32 v245, v245, v14, v14
    v_fma_f32 v246, v246, v14, v14
    v_fma_f32 v247, v247, v14, v14
    v_mfma_f32_32x32x16_bf16 v[160:175], v[236:239], v[24:27], v[160:175]
    ds_read_b128 v[228:231], v4 offset:24576
    v_rcp_f32 v240, v240
    v_rcp_f32 v241, v241
    s_waitcnt lgkmcnt(4)
    v_mfma_f32_32x32x16_bf16 v[160:175], v[208:211], v[28:31], v[160:175]
    ds_read_b128 v[232:235], v4 offset:25600
    s_cbranch_vccz L_wd_81
    buffer_load_dwordx4 a[112:115], v2, s[40:43], s24 offen offset:2048 sc1
    buffer_load_dwordx4 a[116:119], v2, s[40:43], s25 offen offset:2048 sc1
L_wd_81:
    v_rcp_f32 v242, v242
    v_mfma_f32_32x32x16_bf16 v[160:175], v[212:215], v[32:35], v[160:175]
    ds_read_b128 v[236:239], v4 offset:26624
    v_rcp_f32 v243, v243
    v_rcp_f32 v244, v244
    s_waitcnt lgkmcnt(4)
    v_mfma_f32_32x32x16_bf16 v[160:175], v[216:219], v[36:39], v[160:175]
    ds_read_b128 v[208:211], v4 offset:27648
    v_rcp_f32 v245, v245
    v_rcp_f32 v246, v246
    v_mfma_f32_32x32x16_bf16 v[160:175], v[220:223], v[40:43], v[160:175]
    ds_read_b128 v[212:215], v4 offset:28672
    v_rcp_f32 v247, v247
    s_nop 0
    v_mul_f32 v184, v184, v240
    s_waitcnt lgkmcnt(4)
    v_mfma_f32_32x32x16_bf16 v[160:175], v[224:227], v[44:47], v[160:175]
    ds_read_b128 v[216:219], v4 offset:29696
    s_cbranch_vccz L_wd_82
    buffer_load_dwordx4 a[120:123], v2, s[40:43], s24 offen offset:3072 sc1
    buffer_load_dwordx4 a[124:127], v2, s[40:43], s25 offen offset:3072 sc1
L_wd_82:
    v_mul_f32 v185, v185, v241
    v_mul_f32 v186, v186, v242
    v_mul_f32 v187, v187, v243
    v_mfma_f32_32x32x16_bf16 v[160:175], v[228:231], v[48:51], v[160:175]
    ds_read_b128 v[220:223], v4 offset:30720
    v_mul_f32 v188, v188, v244
    v_mul_f32 v189, v189, v245
    v_mul_f32 v190, v190, v246
    v_mul_f32 v191, v191, v247
    s_waitcnt lgkmcnt(4)
    v_mfma_f32_32x32x16_bf16 v[160:175], v[232:235], v[52:55], v[160:175]
    ds_read_b128 v[224:227], v4 offset:31744
    v_cvt_pk_bf16_f32 v248, v184, v185
    v_cvt_pk_bf16_f32 v249, v186, v187
    v_cvt_pk_bf16_f32 v250, v188, v189
    v_cvt_pk_bf16_f32 v251, v190, v191
    v_mfma_f32_32x32x16_bf16 v[160:175], v[236:239], v[56:59], v[160:175]
    ds_read_b128 v[228:231], v5 offset:0
    s_add_u32 s55, s76, 2048
    buffer_store_dwordx4 v[248:251], v2, s[40:43], s55 offen sc1
    s_waitcnt lgkmcnt(4)
    v_mfma_f32_32x32x16_bf16 v[160:175], v[208:211], v[60:63], v[160:175]
    ds_read_b128 v[232:235], v5 offset:1024
    s_cbranch_vccz L_wd_83
    s_add_u32 s24, s16, 16384
    s_add_u32 s25, s17, 16384
    buffer_load_dwordx4 a[128:131], v2, s[40:43], s24 offen offset:0 sc1
    buffer_load_dwordx4 a[132:135], v2, s[40:43], s25 offen offset:0 sc1
L_wd_83:
    v_mul_f32 v240, v192, v192
    v_mul_f32 v241, v193, v193
    v_mul_f32 v242, v194, v194
    v_mfma_f32_32x32x16_bf16 v[160:175], v[212:215], v[64:67], v[160:175]
    ds_read_b128 v[236:239], v5 offset:2048
    v_mul_f32 v243, v195, v195
    v_mul_f32 v244, v196, v196
    v_mul_f32 v245, v197, v197
    v_mul_f32 v246, v198, v198
    s_waitcnt lgkmcnt(4)
    v_mfma_f32_32x32x16_bf16 v[160:175], v[216:219], v[68:71], v[160:175]
    ds_read_b128 v[208:211], v5 offset:3072
    v_mul_f32 v247, v199, v199
    v_fma_f32 v240, v240, v12, v10
    v_fma_f32 v241, v241, v12, v10
    v_fma_f32 v242, v242, v12, v10
    v_mfma_f32_32x32x16_bf16 v[160:175], v[220:223], v[72:75], v[160:175]
    ds_read_b128 v[212:215], v5 offset:4096
    v_fma_f32 v243, v243, v12, v10
    v_fma_f32 v244, v244, v12, v10
    v_fma_f32 v245, v245, v12, v10
    v_fma_f32 v246, v246, v12, v10
    s_waitcnt lgkmcnt(4)
    v_mfma_f32_32x32x16_bf16 v[160:175], v[224:227], v[76:79], v[160:175]
    ds_read_b128 v[216:219], v5 offset:5120
    s_cbranch_vccz L_wd_84
    buffer_load_dwordx4 a[136:139], v2, s[40:43], s24 offen offset:1024 sc1
    buffer_load_dwordx4 a[140:143], v2, s[40:43], s25 offen offset:1024 sc1
L_wd_84:
    v_fma_f32 v247, v247, v12, v10
    v_mul_f32 v240, v240, v192
    v_mul_f32 v241, v241, v193
    v_mfma_f32_32x32x16_bf16 v[160:175], v[228:231], v[80:83], v[160:175]
    ds_read_b128 v[220:223], v5 offset:6144
    v_mul_f32 v242, v242, v194
    v_mul_f32 v243, v243, v195
    v_mul_f32 v244, v244, v196
    v_mul_f32 v245, v245, v197
    s_waitcnt lgkmcnt(4)
    v_mfma_f32_32x32x16_bf16 v[160:175], v[232:235], v[84:87], v[160:175]
    ds_read_b128 v[224:227], v5 offset:7168
    v_mul_f32 v246, v246, v198
    v_mul_f32 v247, v247, v199
    v_exp_f32 v240, v240
    v_mfma_f32_32x32x16_bf16 v[160:175], v[236:239], v[88:91], v[160:175]
    ds_read_b128 v[228:231], v5 offset:8192
    v_mul_f32 v200, v200, v192
    v_exp_f32 v241, v241
    v_mul_f32 v201, v201, v193
    s_waitcnt lgkmcnt(4)
    v_mfma_f32_32x32x16_bf16 v[160:175], v[208:211], v[92:95], v[160:175]
    ds_read_b128 v[232:235], v5 offset:9216
    s_cbranch_vccz L_wd_85
    buffer_load_dwordx4 a[144:147], v2, s[40:43], s24 offen offset:2048 sc1
    buffer_load_dwordx4 a[148:151], v2, s[40:43], s25 offen offset:2048 sc1
L_wd_85:
    v_exp_f32 v242, v242
    v_mul_f32 v202, v202, v194
    v_mfma_f32_32x32x16_bf16 v[160:175], v[212:215], v[96:99], v[160:175]
    ds_read_b128 v[236:239], v5 offset:10240
    v_exp_f32 v243, v243
    v_mul_f32 v203, v203, v195
    s_waitcnt lgkmcnt(4)
    v_mfma_f32_32x32x16_bf16 v[160:175], v[216:219], v[100:103], v[160:175]
    ds_read_b128 v[208:211], v5 offset:11264
    v_exp_f32 v244, v244
    v_mul_f32 v204, v204, v196
    v_mfma_f32_32x32x16_bf16 v[160:175], v[220:223], v[104:107], v[160:175]
    ds_read_b128 v[212:215], v5 offset:12288
    v_exp_f32 v245, v245
    v_mul_f32 v205, v205, v197
    s_waitcnt lgkmcnt(4)
    v_mfma_f32_32x32x16_bf16 v[160:175], v[224:227], v[108:111], v[160:175]
    ds_read_b128 v[216:219], v5 offset:13312
    s_cbranch_vccz L_wd_86
    buffer_load_dwordx4 a[152:155], v2, s[40:43], s24 offen offset:3072 sc1
    buffer_load_dwordx4 a[156:159], v2, s[40:43], s25 offen offset:3072 sc1
L_wd_86:
    v_exp_f32 v246, v246
    v_mul_f32 v206, v206, v198
    v_mfma_f32_32x32x16_bf16 v[160:175], v[228:231], v[112:115], v[160:175]
    ds_read_b128 v[220:223], v5 offset:14336
    v_exp_f32 v247, v247
    v_mul_f32 v207, v207, v199
    v_fma_f32 v240, v240, v14, v14
    s_waitcnt lgkmcnt(4)
    v_mfma_f32_32x32x16_bf16 v[160:175], v[232:235], v[116:119], v[160:175]
    ds_read_b128 v[224:227], v5 offset:15360
    v_fma_f32 v241, v241, v14, v14
    v_fma_f32 v242, v242, v14, v14
    v_fma_f32 v243, v243, v14, v14
    v_fma_f32 v244, v244, v14, v14
    v_mfma_f32_32x32x16_bf16 v[160:175], v[236:239], v[120:123], v[160:175]
    ds_read_b128 v[228:231], v6 offset:5120
    v_fma_f32 v245, v245, v14, v14
    v_fma_f32 v246, v246, v14, v14
    v_fma_f32 v247, v247, v14, v14
    s_waitcnt lgkmcnt(4)
    v_mfma_f32_32x32x16_bf16 v[160:175], v[208:211], v[124:127], v[160:175]
    ds_read_b128 v[232:235], v4 offset:32768
    s_cbranch_vccz L_wd_87
    s_add_u32 s24, s16, 20480
    s_add_u32 s25, s17, 20480
    buffer_load_dwordx4 a[160:163], v2, s[40:43], s24 offen offset:0 sc1
    buffer_load_dwordx4 a[164:167], v2, s[40:43], s25 offen offset:0 sc1
L_wd_87:
    v_rcp_f32 v240, v240
    v_mfma_f32_32x32x16_bf16 v[160:175], v[212:215], v[128:131], v[160:175]
    ds_read_b128 v[236:239], v4 offset:33792
    v_rcp_f32 v241, v241
    v_rcp_f32 v242, v242
    s_waitcnt lgkmcnt(4)
    v_mfma_f32_32x32x16_bf16 v[160:175], v[216:219], v[132:135], v[160:175]
    ds_read_b128 v[208:211], v4 offset:34816
    v_rcp_f32 v243, v243
    v_rcp_f32 v244, v244
    v_mfma_f32_32x32x16_bf16 v[160:175], v[220:223], v[136:139], v[160:175]
    ds_read_b128 v[212:215], v4 offset:35840
    v_rcp_f32 v245, v245
    v_rcp_f32 v246, v246
    s_waitcnt lgkmcnt(4)
    v_mfma_f32_32x32x16_bf16 v[160:175], v[224:227], v[140:143], v[160:175]
    ds_read_b128 v[216:219], v4 offset:36864
    s_cbranch_vccz L_wd_88
    buffer_load_dwordx4 a[168:171], v2, s[40:43], s24 offen offset:1024 sc1
    buffer_load_dwordx4 a[172:175], v2, s[40:43], s25 offen offset:1024 sc1
L_wd_88:
    v_rcp_f32 v247, v247
    s_nop 0
    v_mfma_f32_32x32x16_bf16 v[160:175], v[228:231], v[252:255], v[160:175]
    ds_read_b128 v[220:223], v4 offset:37888
    v_mul_f32 v200, v200, v240
    v_mul_f32 v201, v201, v241
    v_mul_f32 v202, v202, v242
    v_mul_f32 v203, v203, v243
    s_waitcnt lgkmcnt(4)
    v_mfma_f32_32x32x16_bf16 v[176:191], v[232:235], v[16:19], 0
    ds_read_b128 v[224:227], v4 offset:38912
    v_mul_f32 v204, v204, v244
    v_mul_f32 v205, v205, v245
    v_mul_f32 v206, v206, v246
    v_mul_f32 v207, v207, v247
    v_mfma_f32_32x32x16_bf16 v[176:191], v[236:239], v[20:23], v[176:191]
    ds_read_b128 v[228:231], v4 offset:39936
    v_cvt_pk_bf16_f32 v248, v200, v201
    v_cvt_pk_bf16_f32 v249, v202, v203
    v_cvt_pk_bf16_f32 v250, v204, v205
    v_cvt_pk_bf16_f32 v251, v206, v207
    s_waitcnt lgkmcnt(4)
    v_mfma_f32_32x32x16_bf16 v[176:191], v[208:211], v[24:27], v[176:191]
    ds_read_b128 v[232:235], v4 offset:40960
    s_cbranch_vccz L_wd_89
    buffer_load_dwordx4 a[176:179], v2, s[40:43], s24 offen offset:2048 sc1
    buffer_load_dwordx4 a[180:183], v2, s[40:43], s25 offen offset:2048 sc1
L_wd_89:
    s_add_u32 s55, s57, 3072
    buffer_store_dwordx4 v[248:251], v2, s[40:43], s55 offen sc1
    v_mfma_f32_32x32x16_bf16 v[176:191], v[212:215], v[28:31], v[176:191]
    ds_read_b128 v[236:239], v4 offset:41984
    v_mul_f32 v240, v144, v144
    v_mul_f32 v241, v145, v145
    v_mul_f32 v242, v146, v146
    v_mul_f32 v243, v147, v147
    s_waitcnt lgkmcnt(4)
    v_mfma_f32_32x32x16_bf16 v[176:191], v[216:219], v[32:35], v[176:191]
    ds_read_b128 v[208:211], v4 offset:43008
    v_mul_f32 v244, v148, v148
    v_mul_f32 v245, v149, v149
    v_mul_f32 v246, v150, v150
    v_mul_f32 v247, v151, v151
    v_mfma_f32_32x32x16_bf16 v[176:191], v[220:223], v[36:39], v[176:191]
    ds_read_b128 v[212:215], v4 offset:44032
    v_fma_f32 v240, v240, v12, v10
    v_fma_f32 v241, v241, v12, v10
    v_fma_f32 v242, v242, v12, v10
    v_fma_f32 v243, v243, v12, v10
    s_waitcnt lgkmcnt(4)
    v_mfma_f32_32x32x16_bf16 v[176:191], v[224:227], v[40:43], v[176:191]
    ds_read_b128 v[216:219], v4 offset:45056
    s_cbranch_vccz L_wd_90
    buffer_load_dwordx4 a[184:187], v2, s[40:43], s24 offen offset:3072 sc1
    buffer_load_dwordx4 a[188:191], v2, s[40:43], s25 offen offset:3072 sc1
L_wd_90:
    v_fma_f32 v244, v244, v12, v10
    v_fma_f32 v245, v245, v12, v10
    v_fma_f32 v246, v246, v12, v10
    v_mfma_f32_32x32x16_bf16 v[176:191], v[228:231], v[44:47], v[176:191]
    ds_read_b128 v[220:223], v4 offset:46080
    v_fma_f32 v247, v247, v12, v10
    v_mul_f32 v240, v240, v144
    v_mul_f32 v241, v241, v145
    v_mul_f32 v242, v242, v146
    s_waitcnt lgkmcnt(4)
    v_mfma_f32_32x32x16_bf16 v[176:191], v[232:235], v[48:51], v[176:191]
    ds_read_b128 v[224:227], v4 offset:47104
    v_mul_f32 v243, v243, v147
    v_mul_f32 v244, v244, v148
    v_mul_f32 v245, v245, v149
    v_mul_f32 v246, v246, v150
    v_mfma_f32_32x32x16_bf16 v[176:191], v[236:239], v[52:55], v[176:191]
    ds_read_b128 v[228:231], v4 offset:48128
    v_mul_f32 v247, v247, v151
    v_exp_f32 v240, v240
    v_mul_f32 v152, v152, v144
    s_waitcnt lgkmcnt(4)
    v_mfma_f32_32x32x16_bf16 v[176:191], v[208:211], v[56:59], v[176:191]
    ds_read_b128 v[232:235], v5 offset:16384
    s_cbranch_vccz L_wd_91
    s_add_u32 s24, s16, 24576
    s_add_u32 s25, s17, 24576
    buffer_load_dwordx4 a[192:195], v2, s[40:43], s24 offen offset:0 sc1
    buffer_load_dwordx4 a[196:199], v2, s[40:43], s25 offen offset:0 sc1
L_wd_91:
    v_exp_f32 v241, v241
    v_mul_f32 v153, v153, v145
    v_mfma_f32_32x32x16_bf16 v[176:191], v[212:215], v[60:63], v[176:191]
    ds_read_b128 v[236:239], v5 offset:17408
    v_exp_f32 v242, v242
    v_mul_f32 v154, v154, v146
    s_waitcnt lgkmcnt(4)
    v_mfma_f32_32x32x16_bf16 v[176:191], v[216:219], v[64:67], v[176:191]
    ds_read_b128 v[208:211], v5 offset:18432
    v_exp_f32 v243, v243
    v_mul_f32 v155, v155, v147
    v_mfma_f32_32x32x16_bf16 v[176:191], v[220:223], v[68:71], v[176:191]
    ds_read_b128 v[212:215], v5 offset:19456
    v_exp_f32 v244, v244
    v_mul_f32 v156, v156, v148
    s_waitcnt lgkmcnt(4)
    v_mfma_f32_32x32x16_bf16 v[176:191], v[224:227], v[72:75], v[176:191]
    ds_read_b128 v[216:219], v5 offset:20480
    s_cbranch_vccz L_wd_92
    buffer_load_dwordx4 a[200:203], v2, s[40:43], s24 offen offset:1024 sc1
    buffer_load_dwordx4 a[204:207], v2, s[40:43], s25 offen offset:1024 sc1
L_wd_92:
    v_exp_f32 v245, v245
    v_mul_f32 v157, v157, v149
    v_mfma_f32_32x32x16_bf16 v[176:191], v[228:231], v[76:79], v[176:191]
    ds_read_b128 v[220:223], v5 offset:21504
    v_exp_f32 v246, v246
    v_mul_f32 v158, v158, v150
    s_waitcnt lgkmcnt(4)
    v_mfma_f32_32x32x16_bf16 v[176:191], v[232:235], v[80:83], v[176:191]
    ds_read_b128 v[224:227], v5 offset:22528
    v_exp_f32 v247, v247
    v_mul_f32 v159, v159, v151
    v_fma_f32 v240, v240, v14, v14
    v_mfma_f32_32x32x16_bf16 v[176:191], v[236:239], v[84:87], v[176:191]
    ds_read_b128 v[228:231], v5 offset:23552
    v_fma_f32 v241, v241, v14, v14
    v_fma_f32 v242, v242, v14, v14
    v_fma_f32 v243, v243, v14, v14
    v_fma_f32 v244, v244, v14, v14
    s_waitcnt lgkmcnt(4)
    v_mfma_f32_32x32x16_bf16 v[176:191], v[208:211], v[88:91], v[176:191]
    ds_read_b128 v[232:235], v5 offset:24576
    s_cbranch_vccz L_wd_93
    buffer_load_dwordx4 a[208:211], v2, s[40:43], s24 offen offset:2048 sc1
    buffer_load_dwordx4 a[212:215], v2, s[40:43], s25 offen offset:2048 sc1
L_wd_93:
    v_fma_f32 v245, v245, v14, v14
    v_fma_f32 v246, v246, v14, v14
    v_fma_f32 v247, v247, v14, v14
    v_mfma_f32_32x32x16_bf16 v[176:191], v[212:215], v[92:95], v[176:191]
    ds_read_b128 v[236:239], v5 offset:25600
    v_rcp_f32 v240, v240
    v_rcp_f32 v241, v241
    s_waitcnt lgkmcnt(4)
    v_mfma_f32_32x32x16_bf16 v[176:191], v[216:219], v[96:99], v[176:191]
    ds_read_b128 v[208:211], v5 offset:26624
    v_rcp_f32 v242, v242
    v_rcp_f32 v243, v243
    v_mfma_f32_32x32x16_bf16 v[176:191], v[220:223], v[100:103], v[176:191]
    ds_read_b128 v[212:215], v5 offset:27648
    v_rcp_f32 v244, v244
    v_rcp_f32 v245, v245
    s_waitcnt lgkmcnt(4)
    v_mfma_f32_32x32x16_bf16 v[176:191], v[224:227], v[104:107], v[176:191]
    ds_read_b128 v[216:219], v5 offset:28672
    s_cbranch_vccz L_wd_94
    buffer_load_dwordx4 a[216:219], v2, s[40:43], s24 offen offset:3072 sc1
    buffer_load_dwordx4 a[220:223], v2, s[40:43], s25 offen offset:3072 sc1
L_wd_94:
    v_rcp_f32 v246, v246
    v_mfma_f32_32x32x16_bf16 v[176:191], v[228:231], v[108:111], v[176:191]
    ds_read_b128 v[220:223], v5 offset:29696
    v_rcp_f32 v247, v247
    s_nop 0
    v_mul_f32 v152, v152, v240
    s_cmp_lg_u32 s67, 0
    s_cbranch_scc1 L_vl_95
    s_waitcnt vmcnt(10)
    s_branch L_vl_96
L_vl_95:
    s_waitcnt vmcnt(0)
L_vl_96:
    s_barrier
    s_cmp_lg_u32 s50, 0
    s_cbranch_scc1 L_arr_97
    s_mov_b64 exec, 0xffffffff
    v_mov_b32 v3, 1
    buffer_atomic_add v3, v15, s[40:43], 0 offen offset:0 sc1
    s_mov_b64 exec, -1
L_arr_97:
    s_waitcnt lgkmcnt(4)
    v_mfma_f32_32x32x16_bf16 v[176:191], v[232:235], v[112:115], v[176:191]
    ds_read_b128 v[224:227], v5 offset:30720
    v_mul_f32 v153, v153, v241
    v_mul_f32 v154, v154, v242
    v_mul_f32 v155, v155, v243
    v_mul_f32 v156, v156, v244
    v_mfma_f32_32x32x16_bf16 v[176:191], v[236:239], v[116:119], v[176:191]
    ds_read_b128 v[228:231], v5 offset:31744
    v_mul_f32 v157, v157, v245
    v_mul_f32 v158, v158, v246
    v_mul_f32 v159, v159, v247
    v_cvt_pk_bf16_f32 v248, v152, v153
    s_waitcnt lgkmcnt(4)
    v_mfma_f32_32x32x16_bf16 v[176:191], v[208:211], v[120:123], v[176:191]
    ds_read_b128 v[232:235], v6 offset:6144
    v_cvt_pk_bf16_f32 v249, v154, v155
    v_cvt_pk_bf16_f32 v250, v156, v157
    v_cvt_pk_bf16_f32 v251, v158, v159
    s_add_u32 s55, s57, 4096
    buffer_store_dwordx4 v[248:251], v2, s[40:43], s55 offen sc1
    v_mfma_f32_32x32x16_bf16 v[176:191], v[212:215], v[124:127], v[176:191]
    v_mul_f32 v240, v160, v160
    v_mul_f32 v241, v161, v161
    v_mul_f32 v242, v162, v162
    v_mul_f32 v243, v163, v163
    s_waitcnt lgkmcnt(3)
    v_mfma_f32_32x32x16_bf16 v[176:191], v[216:219], v[128:131], v[176:191]
    v_mul_f32 v244, v164, v164
    v_mul_f32 v245, v165, v165
    v_mul_f32 v246, v166, v166
    v_mul_f32 v247, v167, v167
    v_mfma_f32_32x32x16_bf16 v[176:191], v[220:223], v[132:135], v[176:191]
    v_fma_f32 v240, v240, v12, v10
    v_fma_f32 v241, v241, v12, v10
    v_fma_f32 v242, v242, v12, v10
    v_fma_f32 v243, v243, v12, v10
    s_waitcnt lgkmcnt(1)
    v_mfma_f32_32x32x16_bf16 v[176:191], v[224:227], v[136:139], v[176:191]
    v_fma_f32 v244, v244, v12, v10
    v_fma_f32 v245, v245, v12, v10
    v_fma_f32 v246, v246, v12, v10
    v_fma_f32 v247, v247, v12, v10
    v_mfma_f32_32x32x16_bf16 v[176:191], v[228:231], v[140:143], v[176:191]
    v_mul_f32 v240, v240, v160
    v_mul_f32 v241, v241, v161
    v_mul_f32 v242, v242, v162
    v_mul_f32 v243, v243, v163
    s_waitcnt lgkmcnt(0)
    v_mfma_f32_32x32x16_bf16 v[176:191], v[232:235], v[252:255], v[176:191]
    v_mul_f32 v244, v244, v164
    v_mul_f32 v245, v245, v165
    v_mul_f32 v246, v246, v166
    v_mul_f32 v247, v247, v167
    v_exp_f32 v240, v240
    v_mul_f32 v168, v168, v160
    v_exp_f32 v241, v241
    v_mul_f32 v169, v169, v161
    v_exp_f32 v242, v242
    v_mul_f32 v170, v170, v162
    v_exp_f32 v243, v243
    v_mul_f32 v171, v171, v163
    v_exp_f32 v244, v244
    v_mul_f32 v172, v172, v164
    v_exp_f32 v245, v245
    v_mul_f32 v173, v173, v165
    v_exp_f32 v246, v246
    v_mul_f32 v174, v174, v166
    v_exp_f32 v247, v247
    v_mul_f32 v175, v175, v167
    v_fma_f32 v240, v240, v14, v14
    v_fma_f32 v241, v241, v14, v14
    v_fma_f32 v242, v242, v14, v14
    v_fma_f32 v243, v243, v14, v14
    v_fma_f32 v244, v244, v14, v14
    v_fma_f32 v245, v245, v14, v14
    v_fma_f32 v246, v246, v14, v14
    v_fma_f32 v247, v247, v14, v14
    v_rcp_f32 v240, v240
    v_rcp_f32 v241, v241
    v_rcp_f32 v242, v242
    v_rcp_f32 v243, v243
    v_rcp_f32 v244, v244
    v_rcp_f32 v245, v245
    v_rcp_f32 v246, v246
    v_rcp_f32 v247, v247
    s_nop 0
    v_mul_f32 v168, v168, v240
    v_mul_f32 v169, v169, v241
    v_mul_f32 v170, v170, v242
    v_mul_f32 v171, v171, v243
    v_mul_f32 v172, v172, v244
    v_mul_f32 v173, v173, v245
    v_mul_f32 v174, v174, v246
    v_mul_f32 v175, v175, v247
    v_cvt_pk_bf16_f32 v248, v168, v169
    v_cvt_pk_bf16_f32 v249, v170, v171
    v_cvt_pk_bf16_f32 v250, v172, v173
    v_cvt_pk_bf16_f32 v251, v174, v175
    s_add_u32 s55, s57, 5120
    buffer_store_dwordx4 v[248:251], v2, s[40:43], s55 offen sc1
    s_nop 7
    s_nop 3
    v_mul_f32 v240, v176, v176
    v_mul_f32 v241, v177, v177
    v_mul_f32 v242, v178, v178
    v_mul_f32 v243, v179, v179
    v_mul_f32 v244, v180, v180
    v_mul_f32 v245, v181, v181
    v_mul_f32 v246, v182, v182
    v_mul_f32 v247, v183, v183
    v_fma_f32 v240, v240, v12, v10
    v_fma_f32 v241, v241, v12, v10
    v_fma_f32 v242, v242, v12, v10
    v_fma_f32 v243, v243, v12, v10
    v_fma_f32 v244, v244, v12, v10
    v_fma_f32 v245, v245, v12, v10
    v_fma_f32 v246, v246, v12, v10
    v_fma_f32 v247, v247, v12, v10
    v_mul_f32 v240, v240, v176
    v_mul_f32 v241, v241, v177
    v_mul_f32 v242, v242, v178
    v_mul_f32 v243, v243, v179
    v_mul_f32 v244, v244, v180
    v_mul_f32 v245, v245, v181
    v_mul_f32 v246, v246, v182
    v_mul_f32 v247, v247, v183
    v_exp_f32 v240, v240
    v_mul_f32 v184, v184, v176
    v_exp_f32 v241, v241
    v_mul_f32 v185, v185, v177
    v_exp_f32 v242, v242
    v_mul_f32 v186, v186, v178
    v_exp_f32 v243, v243
    v_mul_f32 v187, v187, v179
    v_exp_f32 v244, v244
    v_mul_f32 v188, v188, v180
    v_exp_f32 v245, v245
    v_mul_f32 v189, v189, v181
    v_exp_f32 v246, v246
    v_mul_f32 v190, v190, v182
    v_exp_f32 v247, v247
    v_mul_f32 v191, v191, v183
    s_lshl_b32 s20, s2, 10
    s_lshl_b32 s21, s67, 9
    s_add_u32 s20, s20, s21
    s_add_u32 s20, s20, 30670848
    s_buffer_load_dword s21, s[40:43], s20
    v_fma_f32 v240, v240, v14, v14
    v_fma_f32 v241, v241, v14, v14
    v_fma_f32 v242, v242, v14, v14
    v_fma_f32 v243, v243, v14, v14
    v_fma_f32 v244, v244, v14, v14
    v_fma_f32 v245, v245, v14, v14
    v_fma_f32 v246, v246, v14, v14
    v_fma_f32 v247, v247, v14, v14
    v_rcp_f32 v240, v240
    v_rcp_f32 v241, v241
    v_rcp_f32 v242, v242
    v_rcp_f32 v243, v243
    v_rcp_f32 v244, v244
    v_rcp_f32 v245, v245
    v_rcp_f32 v246, v246
    v_rcp_f32 v247, v247
    s_nop 0
    v_mul_f32 v184, v184, v240
    v_mul_f32 v185, v185, v241
    v_mul_f32 v186, v186, v242
    v_mul_f32 v187, v187, v243
    v_mul_f32 v188, v188, v244
    v_mul_f32 v189, v189, v245
    v_mul_f32 v190, v190, v246
    v_mul_f32 v191, v191, v247
    v_cvt_pk_bf16_f32 v248, v184, v185
    v_cvt_pk_bf16_f32 v249, v186, v187
    v_cvt_pk_bf16_f32 v250, v188, v189
    v_cvt_pk_bf16_f32 v251, v190, v191
    s_add_u32 s55, s57, 6144
    buffer_store_dwordx4 v[248:251], v2, s[40:43], s55 offen sc1
    s_cmp_lg_u32 s67, 0
    s_cbranch_scc1 L_g2_l1
    s_waitcnt lgkmcnt(0)
    s_cmp_ge_u32 s21, 16
    s_cbranch_scc1 L_hok_98
    s_add_u32 s22, s20, 128
    s_buffer_load_dword s21, s[40:43], s22
    s_waitcnt lgkmcnt(0)
    s_cmp_ge_u32 s21, 16
    s_cbranch_scc1 L_hok_98
    s_mov_b64 exec, 1
    v_mov_b32 v4, s20
    s_mov_b32 s60, 0
L_sp_99:
    buffer_load_dword v3, v4, s[40:43], 0 offen sc1
    s_waitcnt vmcnt(0)
    s_add_u32 s60, s60, 1
    v_cmp_le_u32 vcc, 16, v3
    s_nop 0
    s_cmp_eq_u64 vcc, 1
    s_cbranch_scc1 L_spok_100
    s_cmp_lt_u32 s60, 20000
    s_cbranch_scc1 L_sp_99
L_spok_100:
    s_mov_b64 exec, -1
L_hok_98:
    s_mul_i32 s73, s64, 114688
    s_xor_b32 s74, s64, 1
    s_mul_i32 s74, s74, 114688
    s_mul_i32 s57, s50, 28672
    s_add_u32 s57, s57, s69
    s_add_u32 s73, s73, s57
    s_add_u32 s74, s74, s57
    s_add_u32 s52, s73, 0
    buffer_load_dwordx4 v[16:19], v2, s[40:43], s52 offen sc1
    s_add_u32 s52, s74, 0
    buffer_load_dwordx4 v[20:23], v2, s[40:43], s52 offen sc1
    s_add_u32 s52, s73, 7168
    buffer_load_dwordx4 v[24:27], v2, s[40:43], s52 offen sc1
    s_add_u32 s52, s74, 7168
    buffer_load_dwordx4 v[28:31], v2, s[40:43], s52 offen sc1
    s_add_u32 s52, s73, 14336
    buffer_load_dwordx4 v[32:35], v2, s[40:43], s52 offen sc1
    s_add_u32 s52, s74, 14336
    buffer_load_dwordx4 v[36:39], v2, s[40:43], s52 offen sc1
    s_add_u32 s52, s73, 21504
    buffer_load_dwordx4 v[40:43], v2, s[40:43], s52 offen sc1
    s_add_u32 s52, s74, 21504
    buffer_load_dwordx4 v[44:47], v2, s[40:43], s52 offen sc1
    s_add_u32 s52, s73, 1024
    buffer_load_dwordx4 v[48:51], v2, s[40:43], s52 offen sc1
    s_add_u32 s52, s74, 1024
    buffer_load_dwordx4 v[52:55], v2, s[40:43], s52 offen sc1
    s_add_u32 s52, s73, 8192
    buffer_load_dwordx4 v[56:59], v2, s[40:43], s52 offen sc1
    s_add_u32 s52, s74, 8192
    buffer_load_dwordx4 v[60:63], v2, s[40:43], s52 offen sc1
    s_add_u32 s52, s73, 15360
    buffer_load_dwordx4 v[64:67], v2, s[40:43], s52 offen sc1
    s_add_u32 s52, s74, 15360
    buffer_load_dwordx4 v[68:71], v2, s[40:43], s52 offen sc1
    s_add_u32 s52, s73, 22528
    buffer_load_dwordx4 v[72:75], v2, s[40:43], s52 offen sc1
    s_add_u32 s52, s74, 22528
    buffer_load_dwordx4 v[76:79], v2, s[40:43], s52 offen sc1
    s_waitcnt vmcnt(16)
    s_barrier
    s_cmp_lg_u32 s50, 0
    s_cbranch_scc1 L_arr_101
    s_mov_b64 exec, 0xffffffff
    v_mov_b32 v3, 1
    buffer_atomic_add v3, v15, s[40:43], 0 offen offset:256 sc1
    s_mov_b64 exec, -1
L_arr_101:
    s_waitcnt vmcnt(14)
    v_mfma_f32_32x32x16_bf16 v[128:143], a[0:3], v[16:19], 0
    s_add_u32 s52, s73, 2048
    buffer_load_dwordx4 v[80:83], v2, s[40:43], s52 offen sc1
    v_mfma_f32_32x32x16_bf16 v[144:159], a[0:3], v[20:23], 0
    v_mfma_f32_32x32x16_bf16 v[160:175], a[4:7], v[16:19], 0
    s_add_u32 s52, s74, 2048
    buffer_load_dwordx4 v[84:87], v2, s[40:43], s52 offen sc1
    v_mfma_f32_32x32x16_bf16 v[176:191], a[4:7], v[20:23], 0
    s_waitcnt vmcnt(14)
    v_mfma_f32_32x32x16_bf16 v[128:143], a[56:59], v[24:27], v[128:143]
    s_add_u32 s52, s73, 9216
    buffer_load_dwordx4 v[88:91], v2, s[40:43], s52 offen sc1
    v_mfma_f32_32x32x16_bf16 v[144:159], a[56:59], v[28:31], v[144:159]
    v_mfma_f32_32x32x16_bf16 v[160:175], a[60:63], v[24:27], v[160:175]
    s_add_u32 s52, s74, 9216
    buffer_load_dwordx4 v[92:95], v2, s[40:43], s52 offen sc1
    v_mfma_f32_32x32x16_bf16 v[176:191], a[60:63], v[28:31], v[176:191]
    s_waitcnt vmcnt(14)
    v_mfma_f32_32x32x16_bf16 v[128:143], a[112:115], v[32:35], v[128:143]
    s_add_u32 s52, s73, 16384
    buffer_load_dwordx4 v[96:99], v2, s[40:43], s52 offen sc1
    v_mfma_f32_32x32x16_bf16 v[144:159], a[112:115], v[36:39], v[144:159]
    v_mfma_f32_32x32x16_bf16 v[160:175], a[116:119], v[32:35], v[160:175]
    s_add_u32 s52, s74, 16384
    buffer_load_dwordx4 v[100:103], v2, s[40:43], s52 offen sc1
    v_mfma_f32_32x32x16_bf16 v[176:191], a[116:119], v[36:39], v[176:191]
    s_waitcnt vmcnt(14)
    v_mfma_f32_32x32x16_bf16 v[128:143], a[168:171], v[40:43], v[128:143]
    s_add_u32 s52, s73, 23552
    buffer_load_dwordx4 v[104:107], v2, s[40:43], s52 offen sc1
    v_mfma_f32_32x32x16_bf16 v[144:159], a[168:171], v[44:47], v[144:159]
    v_mfma_f32_32x32x16_bf16 v[160:175], a[172:175], v[40:43], v[160:175]
    s_add_u32 s52, s74, 23552
    buffer_load_dwordx4 v[108:111], v2, s[40:43], s52 offen sc1
    v_mfma_f32_32x32x16_bf16 v[176:191], a[172:175], v[44:47], v[176:191]
    s_waitcnt vmcnt(14)
    v_mfma_f32_32x32x16_bf16 v[128:143], a[8:11], v[48:51], v[128:143]
    s_add_u32 s52, s73, 3072
    buffer_load_dwordx4 v[112:115], v2, s[40:43], s52 offen sc1
    v_mfma_f32_32x32x16_bf16 v[144:159], a[8:11], v[52:55], v[144:159]
    v_mfma_f32_32x32x16_bf16 v[160:175], a[12:15], v[48:51], v[160:175]
    s_add_u32 s52, s74, 3072
    buffer_load_dwordx4 v[116:119], v2, s[40:43], s52 offen sc1
    v_mfma_f32_32x32x16_bf16 v[176:191], a[12:15], v[52:55], v[176:191]
    s_waitcnt vmcnt(14)
    v_mfma_f32_32x32x16_bf16 v[128:143], a[64:67], v[56:59], v[128:143]
    s_add_u32 s52, s73, 10240
    buffer_load_dwordx4 v[120:123], v2, s[40:43], s52 offen sc1
    v_mfma_f32_32x32x16_bf16 v[144:159], a[64:67], v[60:63], v[144:159]
    v_mfma_f32_32x32x16_bf16 v[160:175], a[68:71], v[56:59], v[160:175]
    s_add_u32 s52, s74, 10240
    buffer_load_dwordx4 v[124:127], v2, s[40:43], s52 offen sc1
    v_mfma_f32_32x32x16_bf16 v[176:191], a[68:71], v[60:63], v[176:191]
    s_lshl_b32 s20, s2, 10
    s_add_u32 s20, s20, 30671104
    s_buffer_load_dword s21, s[40:43], s20
    s_waitcnt vmcnt(14)
    v_mfma_f32_32x32x16_bf16 v[128:143], a[120:123], v[64:67], v[128:143]
    s_add_u32 s52, s73, 17408
    buffer_load_dwordx4 v[192:195], v2, s[40:43], s52 offen sc1
    v_mfma_f32_32x32x16_bf16 v[144:159], a[120:123], v[68:71], v[144:159]
    v_mfma_f32_32x32x16_bf16 v[160:175], a[124:127], v[64:67], v[160:175]
    s_add_u32 s52, s74, 17408
    buffer_load_dwordx4 v[196:199], v2, s[40:43], s52 offen sc1
    v_mfma_f32_32x32x16_bf16 v[176:191], a[124:127], v[68:71], v[176:191]
    s_waitcnt vmcnt(14)
    v_mfma_f32_32x32x16_bf16 v[128:143], a[176:179], v[72:75], v[128:143]
    s_add_u32 s52, s73, 24576
    buffer_load_dwordx4 v[200:203], v2, s[40:43], s52 offen sc1
    v_mfma_f32_32x32x16_bf16 v[144:159], a[176:179], v[76:79], v[144:159]
    v_mfma_f32_32x32x16_bf16 v[160:175], a[180:183], v[72:75], v[160:175]
    s_add_u32 s52, s74, 24576
    buffer_load_dwordx4 v[204:207], v2, s[40:43], s52 offen sc1
    v_mfma_f32_32x32x16_bf16 v[176:191], a[180:183], v[76:79], v[176:191]
    s_waitcnt vmcnt(14)
    v_mfma_f32_32x32x16_bf16 v[128:143], a[16:19], v[80:83], v[128:143]
    v_mfma_f32_32x32x16_bf16 v[144:159], a[16:19], v[84:87], v[144:159]
    v_mfma_f32_32x32x16_bf16 v[160:175], a[20:23], v[80:83], v[160:175]
    v_mfma_f32_32x32x16_bf16 v[176:191], a[20:23], v[84:87], v[176:191]
    s_waitcnt vmcnt(12)
    v_mfma_f32_32x32x16_bf16 v[128:143], a[72:75], v[88:91], v[128:143]
    v_mfma_f32_32x32x16_bf16 v[144:159], a[72:75], v[92:95], v[144:159]
    v_mfma_f32_32x32x16_bf16 v[160:175], a[76:79], v[88:91], v[160:175]
    v_mfma_f32_32x32x16_bf16 v[176:191], a[76:79], v[92:95], v[176:191]
    s_waitcnt lgkmcnt(0)
    s_cmp_ge_u32 s21, 16
    s_cbranch_scc1 L_hok_102
    s_add_u32 s22, s20, 128
    s_buffer_load_dword s21, s[40:43], s22
    s_waitcnt lgkmcnt(0)
    s_cmp_ge_u32 s21, 16
    s_cbranch_scc1 L_hok_102
    s_mov_b64 exec, 1
    v_mov_b32 v4, s20
    s_mov_b32 s60, 0
L_sp_103:
    buffer_load_dword v3, v4, s[40:43], 0 offen sc1
    s_waitcnt vmcnt(0)
    s_add_u32 s60, s60, 1
    v_cmp_le_u32 vcc, 16, v3
    s_nop 0
    s_cmp_eq_u64 vcc, 1
    s_cbranch_scc1 L_spok_104
    s_cmp_lt_u32 s60, 20000
    s_cbranch_scc1 L_sp_103
L_spok_104:
    s_mov_b64 exec, -1
L_hok_102:
    s_waitcnt vmcnt(10)
    v_mfma_f32_32x32x16_bf16 v[128:143], a[128:131], v[96:99], v[128:143]
    s_add_u32 s52, s73, 4096
    buffer_load_dwordx4 v[208:211], v2, s[40:43], s52 offen sc1
    s_add_u32 s52, s74, 4096
    buffer_load_dwordx4 v[212:215], v2, s[40:43], s52 offen sc1
    s_add_u32 s52, s73, 11264
    buffer_load_dwordx4 v[216:219], v2, s[40:43], s52 offen sc1
    v_mfma_f32_32x32x16_bf16 v[144:159], a[128:131], v[100:103], v[144:159]
    s_add_u32 s52, s74, 11264
    buffer_load_dwordx4 v[220:223], v2, s[40:43], s52 offen sc1
    s_add_u32 s52, s73, 18432
    buffer_load_dwordx4 v[224:227], v2, s[40:43], s52 offen sc1
    s_add_u32 s52, s74, 18432
    buffer_load_dwordx4 v[228:231], v2, s[40:43], s52 offen sc1
    v_mfma_f32_32x32x16_bf16 v[160:175], a[132:135], v[96:99], v[160:175]
    v_mfma_f32_32x32x16_bf16 v[176:191], a[132:135], v[100:103], v[176:191]
    s_waitcnt vmcnt(14)
    v_mfma_f32_32x32x16_bf16 v[128:143], a[184:187], v[104:107], v[128:143]
    s_add_u32 s52, s73, 25600
    buffer_load_dwordx4 v[232:235], v2, s[40:43], s52 offen sc1
    v_mfma_f32_32x32x16_bf16 v[144:159], a[184:187], v[108:111], v[144:159]
    v_mfma_f32_32x32x16_bf16 v[160:175], a[188:191], v[104:107], v[160:175]
    s_add_u32 s52, s74, 25600
    buffer_load_dwordx4 v[236:239], v2, s[40:43], s52 offen sc1
    v_mfma_f32_32x32x16_bf16 v[176:191], a[188:191], v[108:111], v[176:191]
    s_waitcnt vmcnt(14)
    v_mfma_f32_32x32x16_bf16 v[128:143], a[24:27], v[112:115], v[128:143]
    s_add_u32 s52, s73, 5120
    buffer_load_dwordx4 v[240:243], v2, s[40:43], s52 offen sc1
    v_mfma_f32_32x32x16_bf16 v[144:159], a[24:27], v[116:119], v[144:159]
    v_mfma_f32_32x32x16_bf16 v[160:175], a[28:31], v[112:115], v[160:175]
    s_add_u32 s52, s74, 5120
    buffer_load_dwordx4 v[244:247], v2, s[40:43], s52 offen sc1
    v_mfma_f32_32x32x16_bf16 v[176:191], a[28:31], v[116:119], v[176:191]
    s_waitcnt vmcnt(14)
    v_mfma_f32_32x32x16_bf16 v[128:143], a[80:83], v[120:123], v[128:143]
    s_add_u32 s52, s73, 12288
    buffer_load_dwordx4 v[248:251], v2, s[40:43], s52 offen sc1
    v_mfma_f32_32x32x16_bf16 v[144:159], a[80:83], v[124:127], v[144:159]
    v_mfma_f32_32x32x16_bf16 v[160:175], a[84:87], v[120:123], v[160:175]
    s_add_u32 s52, s74, 12288
    buffer_load_dwordx4 v[252:255], v2, s[40:43], s52 offen sc1
    v_mfma_f32_32x32x16_bf16 v[176:191], a[84:87], v[124:127], v[176:191]
    s_waitcnt vmcnt(14)
    v_mfma_f32_32x32x16_bf16 v[128:143], a[136:139], v[192:195], v[128:143]
    s_add_u32 s52, s73, 19456
    buffer_load_dwordx4 v[16:19], v2, s[40:43], s52 offen sc1
    v_mfma_f32_32x32x16_bf16 v[144:159], a[136:139], v[196:199], v[144:159]
    v_mfma_f32_32x32x16_bf16 v[160:175], a[140:143], v[192:195], v[160:175]
    s_add_u32 s52, s74, 19456
    buffer_load_dwordx4 v[20:23], v2, s[40:43], s52 offen sc1
    v_mfma_f32_32x32x16_bf16 v[176:191], a[140:143], v[196:199], v[176:191]
    s_waitcnt vmcnt(14)
    v_mfma_f32_32x32x16_bf16 v[128:143], a[192:195], v[200:203], v[128:143]
    s_add_u32 s52, s73, 26624
    buffer_load_dwordx4 v[24:27], v2, s[40:43], s52 offen sc1
    v_mfma_f32_32x32x16_bf16 v[144:159], a[192:195], v[204:207], v[144:159]
    v_mfma_f32_32x32x16_bf16 v[160:175], a[196:199], v[200:203], v[160:175]
    s_add_u32 s52, s74, 26624
    buffer_load_dwordx4 v[28:31], v2, s[40:43], s52 offen sc1
    v_mfma_f32_32x32x16_bf16 v[176:191], a[196:199], v[204:207], v[176:191]
    s_waitcnt vmcnt(14)
    v_mfma_f32_32x32x16_bf16 v[128:143], a[32:35], v[208:211], v[128:143]
    s_add_u32 s52, s73, 6144
    buffer_load_dwordx4 v[32:35], v2, s[40:43], s52 offen sc1
    v_mfma_f32_32x32x16_bf16 v[144:159], a[32:35], v[212:215], v[144:159]
    v_mfma_f32_32x32x16_bf16 v[160:175], a[36:39], v[208:211], v[160:175]
    s_add_u32 s52, s74, 6144
    buffer_load_dwordx4 v[36:39], v2, s[40:43], s52 offen sc1
    v_mfma_f32_32x32x16_bf16 v[176:191], a[36:39], v[212:215], v[176:191]
    s_waitcnt vmcnt(14)
    v_mfma_f32_32x32x16_bf16 v[128:143], a[88:91], v[216:219], v[128:143]
    s_add_u32 s52, s73, 13312
    buffer_load_dwordx4 v[40:43], v2, s[40:43], s52 offen sc1
    v_mfma_f32_32x32x16_bf16 v[144:159], a[88:91], v[220:223], v[144:159]
    v_mfma_f32_32x32x16_bf16 v[160:175], a[92:95], v[216:219], v[160:175]
    s_add_u32 s52, s74, 13312
    buffer_load_dwordx4 v[44:47], v2, s[40:43], s52 offen sc1
    v_mfma_f32_32x32x16_bf16 v[176:191], a[92:95], v[220:223], v[176:191]
    s_waitcnt vmcnt(14)
    v_mfma_f32_32x32x16_bf16 v[128:143], a[144:147], v[224:227], v[128:143]
    s_add_u32 s52, s73, 20480
    buffer_load_dwordx4 v[48:51], v2, s[40:43], s52 offen sc1
    v_mfma_f32_32x32x16_bf16 v[144:159], a[144:147], v[228:231], v[144:159]
    v_mfma_f32_32x32x16_bf16 v[160:175], a[148:151], v[224:227], v[160:175]
    s_add_u32 s52, s74, 20480
    buffer_load_dwordx4 v[52:55], v2, s[40:43], s52 offen sc1
    v_mfma_f32_32x32x16_bf16 v[176:191], a[148:151], v[228:231], v[176:191]
    s_waitcnt vmcnt(14)
    v_mfma_f32_32x32x16_bf16 v[128:143], a[200:203], v[232:235], v[128:143]
    s_add_u32 s52, s73, 27648
    buffer_load_dwordx4 v[56:59], v2, s[40:43], s52 offen sc1
    v_mfma_f32_32x32x16_bf16 v[144:159], a[200:203], v[236:239], v[144:159]
    v_mfma_f32_32x32x16_bf16 v[160:175], a[204:207], v[232:235], v[160:175]
    s_add_u32 s52, s74, 27648
    buffer_load_dwordx4 v[60:63], v2, s[40:43], s52 offen sc1
    v_mfma_f32_32x32x16_bf16 v[176:191], a[204:207], v[236:239], v[176:191]
    s_waitcnt vmcnt(14)
    v_mfma_f32_32x32x16_bf16 v[128:143], a[40:43], v[240:243], v[128:143]
    v_accvgpr_read_b32 v64, a232
    v_accvgpr_read_b32 v65, a233
    v_mfma_f32_32x32x16_bf16 v[144:159], a[40:43], v[244:247], v[144:159]
    v_accvgpr_read_b32 v66, a234
    v_accvgpr_read_b32 v67, a235
    v_mfma_f32_32x32x16_bf16 v[160:175], a[44:47], v[240:243], v[160:175]
    v_accvgpr_read_b32 v68, a236
    v_accvgpr_read_b32 v69, a237
    v_mfma_f32_32x32x16_bf16 v[176:191], a[44:47], v[244:247], v[176:191]
    v_accvgpr_read_b32 v70, a238
    v_accvgpr_read_b32 v71, a239
    s_waitcnt vmcnt(12)
    v_mfma_f32_32x32x16_bf16 v[128:143], a[96:99], v[248:251], v[128:143]
    v_lshlrev_b32 v72, 16, v64
    v_and_b32 v73, 0xffff0000, v64
    v_mfma_f32_32x32x16_bf16 v[144:159], a[96:99], v[252:255], v[144:159]
    v_lshlrev_b32 v74, 16, v65
    v_and_b32 v75, 0xffff0000, v65
    v_mfma_f32_32x32x16_bf16 v[160:175], a[100:103], v[248:251], v[160:175]
    v_lshlrev_b32 v76, 16, v66
    v_and_b32 v77, 0xffff0000, v66
    v_mfma_f32_32x32x16_bf16 v[176:191], a[100:103], v[252:255], v[176:191]
    v_lshlrev_b32 v78, 16, v67
    v_and_b32 v79, 0xffff0000, v67
    s_waitcnt vmcnt(10)
    v_mfma_f32_32x32x16_bf16 v[128:143], a[152:155], v[16:19], v[128:143]
    v_lshlrev_b32 v80, 16, v68
    v_and_b32 v81, 0xffff0000, v68
    v_mfma_f32_32x32x16_bf16 v[144:159], a[152:155], v[20:23], v[144:159]
    v_lshlrev_b32 v82, 16, v69
    v_and_b32 v83, 0xffff0000, v69
    v_mfma_f32_32x32x16_bf16 v[160:175], a[156:159], v[16:19], v[160:175]
    v_lshlrev_b32 v84, 16, v70
    v_and_b32 v85, 0xffff0000, v70
    v_mfma_f32_32x32x16_bf16 v[176:191], a[156:159], v[20:23], v[176:191]
    v_lshlrev_b32 v86, 16, v71
    v_and_b32 v87, 0xffff0000, v71
    s_waitcnt vmcnt(8)
    v_mfma_f32_32x32x16_bf16 v[128:143], a[208:211], v[24:27], v[128:143]
    s_xor_b32 s55, s50, 1
    s_mul_i32 s55, s55, 12288
    v_mfma_f32_32x32x16_bf16 v[144:159], a[208:211], v[28:31], v[144:159]
    s_add_u32 s55, s55, 98304
    v_add_u32 v4, s55, v2
    v_mfma_f32_32x32x16_bf16 v[160:175], a[212:215], v[24:27], v[160:175]
    s_xor_b32 s55, s50, 2
    s_mul_i32 s55, s55, 12288
    v_mfma_f32_32x32x16_bf16 v[176:191], a[212:215], v[28:31], v[176:191]
    s_add_u32 s55, s55, 102400
    v_add_u32 v5, s55, v2
    s_waitcnt vmcnt(6)
    v_mfma_f32_32x32x16_bf16 v[128:143], a[48:51], v[32:35], v[128:143]
    s_xor_b32 s55, s50, 3
    s_mul_i32 s55, s55, 12288
    v_mfma_f32_32x32x16_bf16 v[144:159], a[48:51], v[36:39], v[144:159]
    s_add_u32 s55, s55, 106496
    v_add_u32 v6, s55, v2
    v_mfma_f32_32x32x16_bf16 v[160:175], a[52:55], v[32:35], v[160:175]
    s_mul_i32 s55, s50, 12288
    s_add_u32 s55, s55, 98304
    v_mfma_f32_32x32x16_bf16 v[176:191], a[52:55], v[36:39], v[176:191]
    v_add_u32 v3, s55, v2
    s_waitcnt vmcnt(4)
    v_mfma_f32_32x32x16_bf16 v[128:143], a[104:107], v[40:43], v[128:143]
    v_mfma_f32_32x32x16_bf16 v[144:159], a[104:107], v[44:47], v[144:159]
    v_mfma_f32_32x32x16_bf16 v[160:175], a[108:111], v[40:43], v[160:175]
    v_mfma_f32_32x32x16_bf16 v[176:191], a[108:111], v[44:47], v[176:191]
    s_waitcnt vmcnt(2)
    v_mfma_f32_32x32x16_bf16 v[128:143], a[160:163], v[48:51], v[128:143]
    v_mfma_f32_32x32x16_bf16 v[144:159], a[160:163], v[52:55], v[144:159]
    v_mfma_f32_32x32x16_bf16 v[160:175], a[164:167], v[48:51], v[160:175]
    v_mfma_f32_32x32x16_bf16 v[176:191], a[164:167], v[52:55], v[176:191]
    s_waitcnt vmcnt(0)
    v_mfma_f32_32x32x16_bf16 v[128:143], a[216:219], v[56:59], v[128:143]
    v_mfma_f32_32x32x16_bf16 v[144:159], a[216:219], v[60:63], v[144:159]
    v_mfma_f32_32x32x16_bf16 v[160:175], a[220:223], v[56:59], v[160:175]
    v_mfma_f32_32x32x16_bf16 v[176:191], a[220:223], v[60:63], v[176:191]
    s_branch L_g2_tail
L_g2_l1:
    s_waitcnt lgkmcnt(0)
    s_cmp_ge_u32 s21, 16
    s_cbranch_scc1 L_hok_105
    s_add_u32 s22, s20, 128
    s_buffer_load_dword s21, s[40:43], s22
    s_waitcnt lgkmcnt(0)
    s_cmp_ge_u32 s21, 16
    s_cbranch_scc1 L_hok_105
    s_mov_b64 exec, 1
    v_mov_b32 v4, s20
    s_mov_b32 s60, 0
L_sp_106:
    buffer_load_dword v3, v4, s[40:43], 0 offen sc1
    s_waitcnt vmcnt(0)
    s_add_u32 s60, s60, 1
    v_cmp_le_u32 vcc, 16, v3
    s_nop 0
    s_cmp_eq_u64 vcc, 1
    s_cbranch_scc1 L_spok_107
    s_cmp_lt_u32 s60, 20000
    s_cbranch_scc1 L_sp_106
L_spok_107:
    s_mov_b64 exec, -1
L_hok_105:
    s_mul_i32 s73, s64, 114688
    s_xor_b32 s74, s64, 1
    s_mul_i32 s74, s74, 114688
    s_mul_i32 s57, s50, 28672
    s_add_u32 s57, s57, s69
    s_add_u32 s73, s73, s57
    s_add_u32 s74, s74, s57
    s_add_u32 s52, s73, 4096
    buffer_load_dwordx4 v[16:19], v2, s[40:43], s52 offen sc1
    s_add_u32 s52, s74, 4096
    buffer_load_dwordx4 v[20:23], v2, s[40:43], s52 offen sc1
    s_add_u32 s52, s73, 11264
    buffer_load_dwordx4 v[24:27], v2, s[40:43], s52 offen sc1
    s_add_u32 s52, s74, 11264
    buffer_load_dwordx4 v[28:31], v2, s[40:43], s52 offen sc1
    s_add_u32 s52, s73, 18432
    buffer_load_dwordx4 v[32:35], v2, s[40:43], s52 offen sc1
    s_add_u32 s52, s74, 18432
    buffer_load_dwordx4 v[36:39], v2, s[40:43], s52 offen sc1
    s_add_u32 s52, s73, 25600
    buffer_load_dwordx4 v[40:43], v2, s[40:43], s52 offen sc1
    s_add_u32 s52, s74, 25600
    buffer_load_dwordx4 v[44:47], v2, s[40:43], s52 offen sc1
    s_add_u32 s52, s73, 5120
    buffer_load_dwordx4 v[48:51], v2, s[40:43], s52 offen sc1
    s_add_u32 s52, s74, 5120
    buffer_load_dwordx4 v[52:55], v2, s[40:43], s52 offen sc1
    s_add_u32 s52, s73, 12288
    buffer_load_dwordx4 v[56:59], v2, s[40:43], s52 offen sc1
    s_add_u32 s52, s74, 12288
    buffer_load_dwordx4 v[60:63], v2, s[40:43], s52 offen sc1
    s_add_u32 s52, s73, 19456
    buffer_load_dwordx4 v[64:67], v2, s[40:43], s52 offen sc1
    s_add_u32 s52, s74, 19456
    buffer_load_dwordx4 v[68:71], v2, s[40:43], s52 offen sc1
    s_add_u32 s52, s73, 26624
    buffer_load_dwordx4 v[72:75], v2, s[40:43], s52 offen sc1
    s_add_u32 s52, s74, 26624
    buffer_load_dwordx4 v[76:79], v2, s[40:43], s52 offen sc1
    s_waitcnt vmcnt(16)
    s_barrier
    s_cmp_lg_u32 s50, 0
    s_cbranch_scc1 L_arr_108
    s_mov_b64 exec, 0xffffffff
    v_mov_b32 v3, 1
    buffer_atomic_add v3, v15, s[40:43], 0 offen offset:256 sc1
    s_mov_b64 exec, -1
L_arr_108:
    s_waitcnt vmcnt(14)
    v_mfma_f32_32x32x16_bf16 v[128:143], a[32:35], v[16:19], 0
    s_add_u32 s52, s73, 6144
    buffer_load_dwordx4 v[80:83], v2, s[40:43], s52 offen sc1
    v_mfma_f32_32x32x16_bf16 v[144:159], a[32:35], v[20:23], 0
    v_mfma_f32_32x32x16_bf16 v[160:175], a[36:39], v[16:19], 0
    s_add_u32 s52, s74, 6144
    buffer_load_dwordx4 v[84:87], v2, s[40:43], s52 offen sc1
    v_mfma_f32_32x32x16_bf16 v[176:191], a[36:39], v[20:23], 0
    s_waitcnt vmcnt(14)
    v_mfma_f32_32x32x16_bf16 v[128:143], a[88:91], v[24:27], v[128:143]
    s_add_u32 s52, s73, 13312
    buffer_load_dwordx4 v[88:91], v2, s[40:43], s52 offen sc1
    v_mfma_f32_32x32x16_bf16 v[144:159], a[88:91], v[28:31], v[144:159]
    v_mfma_f32_32x32x16_bf16 v[160:175], a[92:95], v[24:27], v[160:175]
    s_add_u32 s52, s74, 13312
    buffer_load_dwordx4 v[92:95], v2, s[40:43], s52 offen sc1
    v_mfma_f32_32x32x16_bf16 v[176:191], a[92:95], v[28:31], v[176:191]
    s_waitcnt vmcnt(14)
    v_mfma_f32_32x32x16_bf16 v[128:143], a[144:147], v[32:35], v[128:143]
    s_add_u32 s52, s73, 20480
    buffer_load_dwordx4 v[96:99], v2, s[40:43], s52 offen sc1
    v_mfma_f32_32x32x16_bf16 v[144:159], a[144:147], v[36:39], v[144:159]
    v_mfma_f32_32x32x16_bf16 v[160:175], a[148:151], v[32:35], v[160:175]
    s_add_u32 s52, s74, 20480
    buffer_load_dwordx4 v[100:103], v2, s[40:43], s52 offen sc1
    v_mfma_f32_32x32x16_bf16 v[176:191], a[148:151], v[36:39], v[176:191]
    s_waitcnt vmcnt(14)
    v_mfma_f32_32x32x16_bf16 v[128:143], a[200:203], v[40:43], v[128:143]
    s_add_u32 s52, s73, 27648
    buffer_load_dwordx4 v[104:107], v2, s[40:43], s52 offen sc1
    v_mfma_f32_32x32x16_bf16 v[144:159], a[200:203], v[44:47], v[144:159]
    v_mfma_f32_32x32x16_bf16 v[160:175], a[204:207], v[40:43], v[160:175]
    s_add_u32 s52, s74, 27648
    buffer_load_dwordx4 v[108:111], v2, s[40:43], s52 offen sc1
    v_mfma_f32_32x32x16_bf16 v[176:191], a[204:207], v[44:47], v[176:191]
    s_waitcnt vmcnt(14)
    v_mfma_f32_32x32x16_bf16 v[128:143], a[40:43], v[48:51], v[128:143]
    s_add_u32 s52, s73, 0
    buffer_load_dwordx4 v[112:115], v2, s[40:43], s52 offen sc1
    v_mfma_f32_32x32x16_bf16 v[144:159], a[40:43], v[52:55], v[144:159]
    v_mfma_f32_32x32x16_bf16 v[160:175], a[44:47], v[48:51], v[160:175]
    s_add_u32 s52, s74, 0
    buffer_load_dwordx4 v[116:119], v2, s[40:43], s52 offen sc1
    v_mfma_f32_32x32x16_bf16 v[176:191], a[44:47], v[52:55], v[176:191]
    s_waitcnt vmcnt(14)
    v_mfma_f32_32x32x16_bf16 v[128:143], a[96:99], v[56:59], v[128:143]
    s_add_u32 s52, s73, 7168
    buffer_load_dwordx4 v[120:123], v2, s[40:43], s52 offen sc1
    v_mfma_f32_32x32x16_bf16 v[144:159], a[96:99], v[60:63], v[144:159]
    v_mfma_f32_32x32x16_bf16 v[160:175], a[100:103], v[56:59], v[160:175]
    s_add_u32 s52, s74, 7168
    buffer_load_dwordx4 v[124:127], v2, s[40:43], s52 offen sc1
    v_mfma_f32_32x32x16_bf16 v[176:191], a[100:103], v[60:63], v[176:191]
    s_lshl_b32 s20, s2, 10
    s_add_u32 s20, s20, 30671616
    s_buffer_load_dword s21, s[40:43], s20
    s_waitcnt vmcnt(14)
    v_mfma_f32_32x32x16_bf16 v[128:143], a[152:155], v[64:67], v[128:143]
    s_add_u32 s52, s73, 14336
    buffer_load_dwordx4 v[192:195], v2, s[40:43], s52 offen sc1
    v_mfma_f32_32x32x16_bf16 v[144:159], a[152:155], v[68:71], v[144:159]
    v_mfma_f32_32x32x16_bf16 v[160:175], a[156:159], v[64:67], v[160:175]
    s_add_u32 s52, s74, 14336
    buffer_load_dwordx4 v[196:199], v2, s[40:43], s52 offen sc1
    v_mfma_f32_32x32x16_bf16 v[176:191], a[156:159], v[68:71], v[176:191]
    s_waitcnt vmcnt(14)
    v_mfma_f32_32x32x16_bf16 v[128:143], a[208:211], v[72:75], v[128:143]
    s_add_u32 s52, s73, 21504
    buffer_load_dwordx4 v[200:203], v2, s[40:43], s52 offen sc1
    v_mfma_f32_32x32x16_bf16 v[144:159], a[208:211], v[76:79], v[144:159]
    v_mfma_f32_32x32x16_bf16 v[160:175], a[212:215], v[72:75], v[160:175]
    s_add_u32 s52, s74, 21504
    buffer_load_dwordx4 v[204:207], v2, s[40:43], s52 offen sc1
    v_mfma_f32_32x32x16_bf16 v[176:191], a[212:215], v[76:79], v[176:191]
    s_waitcnt vmcnt(14)
    v_mfma_f32_32x32x16_bf16 v[128:143], a[48:51], v[80:83], v[128:143]
    v_mfma_f32_32x32x16_bf16 v[144:159], a[48:51], v[84:87], v[144:159]
    v_mfma_f32_32x32x16_bf16 v[160:175], a[52:55], v[80:83], v[160:175]
    v_mfma_f32_32x32x16_bf16 v[176:191], a[52:55], v[84:87], v[176:191]
    s_waitcnt vmcnt(12)
    v_mfma_f32_32x32x16_bf16 v[128:143], a[104:107], v[88:91], v[128:143]
    v_mfma_f32_32x32x16_bf16 v[144:159], a[104:107], v[92:95], v[144:159]
    v_mfma_f32_32x32x16_bf16 v[160:175], a[108:111], v[88:91], v[160:175]
    v_mfma_f32_32x32x16_bf16 v[176:191], a[108:111], v[92:95], v[176:191]
    s_waitcnt lgkmcnt(0)
    s_cmp_ge_u32 s21, 16
    s_cbranch_scc1 L_hok_109
    s_add_u32 s22, s20, 128
    s_buffer_load_dword s21, s[40:43], s22
    s_waitcnt lgkmcnt(0)
    s_cmp_ge_u32 s21, 16
    s_cbranch_scc1 L_hok_109
    s_mov_b64 exec, 1
    v_mov_b32 v4, s20
    s_mov_b32 s60, 0
L_sp_110:
    buffer_load_dword v3, v4, s[40:43], 0 offen sc1
    s_waitcnt vmcnt(0)
    s_add_u32 s60, s60, 1
    v_cmp_le_u32 vcc, 16, v3
    s_nop 0
    s_cmp_eq_u64 vcc, 1
    s_cbranch_scc1 L_spok_111
    s_cmp_lt_u32 s60, 20000
    s_cbranch_scc1 L_sp_110
L_spok_111:
    s_mov_b64 exec, -1
L_hok_109:
    s_waitcnt vmcnt(10)
    v_mfma_f32_32x32x16_bf16 v[128:143], a[160:163], v[96:99], v[128:143]
    s_add_u32 s52, s73, 1024
    buffer_load_dwordx4 v[208:211], v2, s[40:43], s52 offen sc1
    s_add_u32 s52, s74, 1024
    buffer_load_dwordx4 v[212:215], v2, s[40:43], s52 offen sc1
    s_add_u32 s52, s73, 8192
    buffer_load_dwordx4 v[216:219], v2, s[40:43], s52 offen sc1
    v_mfma_f32_32x32x16_bf16 v[144:159], a[160:163], v[100:103], v[144:159]
    s_add_u32 s52, s74, 8192
    buffer_load_dwordx4 v[220:223], v2, s[40:43], s52 offen sc1
    s_add_u32 s52, s73, 15360
    buffer_load_dwordx4 v[224:227], v2, s[40:43], s52 offen sc1
    s_add_u32 s52, s74, 15360
    buffer_load_dwordx4 v[228:231], v2, s[40:43], s52 offen sc1
    v_mfma_f32_32x32x16_bf16 v[160:175], a[164:167], v[96:99], v[160:175]
    v_mfma_f32_32x32x16_bf16 v[176:191], a[164:167], v[100:103], v[176:191]
    s_waitcnt vmcnt(14)
    v_mfma_f32_32x32x16_bf16 v[128:143], a[216:219], v[104:107], v[128:143]
    s_add_u32 s52, s73, 22528
    buffer_load_dwordx4 v[232:235], v2, s[40:43], s52 offen sc1
    v_mfma_f32_32x32x16_bf16 v[144:159], a[216:219], v[108:111], v[144:159]
    v_mfma_f32_32x32x16_bf16 v[160:175], a[220:223], v[104:107], v[160:175]
    s_add_u32 s52, s74, 22528
    buffer_load_dwordx4 v[236:239], v2, s[40:43], s52 offen sc1
    v_mfma_f32_32x32x16_bf16 v[176:191], a[220:223], v[108:111], v[176:191]
    s_waitcnt vmcnt(14)
    v_mfma_f32_32x32x16_bf16 v[128:143], a[0:3], v[112:115], v[128:143]
    s_add_u32 s52, s73, 2048
    buffer_load_dwordx4 v[240:243], v2, s[40:43], s52 offen sc1
    v_mfma_f32_32x32x16_bf16 v[144:159], a[0:3], v[116:119], v[144:159]
    v_mfma_f32_32x32x16_bf16 v[160:175], a[4:7], v[112:115], v[160:175]
    s_add_u32 s52, s74, 2048
    buffer_load_dwordx4 v[244:247], v2, s[40:43], s52 offen sc1
    v_mfma_f32_32x32x16_bf16 v[176:191], a[4:7], v[116:119], v[176:191]
    s_waitcnt vmcnt(14)
    v_mfma_f32_32x32x16_bf16 v[128:143], a[56:59], v[120:123], v[128:143]
    s_add_u32 s52, s73, 9216
    buffer_load_dwordx4 v[248:251], v2, s[40:43], s52 offen sc1
    v_mfma_f32_32x32x16_bf16 v[144:159], a[56:59], v[124:127], v[144:159]
    v_mfma_f32_32x32x16_bf16 v[160:175], a[60:63], v[120:123], v[160:175]
    s_add_u32 s52, s74, 9216
    buffer_load_dwordx4 v[252:255], v2, s[40:43], s52 offen sc1
    v_mfma_f32_32x32x16_bf16 v[176:191], a[60:63], v[124:127], v[176:191]
    s_waitcnt vmcnt(14)
    v_mfma_f32_32x32x16_bf16 v[128:143], a[112:115], v[192:195], v[128:143]
    s_add_u32 s52, s73, 16384
    buffer_load_dwordx4 v[16:19], v2, s[40:43], s52 offen sc1
    v_mfma_f32_32x32x16_bf16 v[144:159], a[112:115], v[196:199], v[144:159]
    v_mfma_f32_32x32x16_bf16 v[160:175], a[116:119], v[192:195], v[160:175]
    s_add_u32 s52, s74, 16384
    buffer_load_dwordx4 v[20:23], v2, s[40:43], s52 offen sc1
    v_mfma_f32_32x32x16_bf16 v[176:191], a[116:119], v[196:199], v[176:191]
    s_waitcnt vmcnt(14)
    v_mfma_f32_32x32x16_bf16 v[128:143], a[168:171], v[200:203], v[128:143]
    s_add_u32 s52, s73, 23552
    buffer_load_dwordx4 v[24:27], v2, s[40:43], s52 offen sc1
    v_mfma_f32_32x32x16_bf16 v[144:159], a[168:171], v[204:207], v[144:159]
    v_mfma_f32_32x32x16_bf16 v[160:175], a[172:175], v[200:203], v[160:175]
    s_add_u32 s52, s74, 23552
    buffer_load_dwordx4 v[28:31], v2, s[40:43], s52 offen sc1
    v_mfma_f32_32x32x16_bf16 v[176:191], a[172:175], v[204:207], v[176:191]
    s_waitcnt vmcnt(14)
    v_mfma_f32_32x32x16_bf16 v[128:143], a[8:11], v[208:211], v[128:143]
    s_add_u32 s52, s73, 3072
    buffer_load_dwordx4 v[32:35], v2, s[40:43], s52 offen sc1
    v_mfma_f32_32x32x16_bf16 v[144:159], a[8:11], v[212:215], v[144:159]
    v_mfma_f32_32x32x16_bf16 v[160:175], a[12:15], v[208:211], v[160:175]
    s_add_u32 s52, s74, 3072
    buffer_load_dwordx4 v[36:39], v2, s[40:43], s52 offen sc1
    v_mfma_f32_32x32x16_bf16 v[176:191], a[12:15], v[212:215], v[176:191]
    s_waitcnt vmcnt(14)
    v_mfma_f32_32x32x16_bf16 v[128:143], a[64:67], v[216:219], v[128:143]
    s_add_u32 s52, s73, 10240
    buffer_load_dwordx4 v[40:43], v2, s[40:43], s52 offen sc1
    v_mfma_f32_32x32x16_bf16 v[144:159], a[64:67], v[220:223], v[144:159]
    v_mfma_f32_32x32x16_bf16 v[160:175], a[68:71], v[216:219], v[160:175]
    s_add_u32 s52, s74, 10240
    buffer_load_dwordx4 v[44:47], v2, s[40:43], s52 offen sc1
    v_mfma_f32_32x32x16_bf16 v[176:191], a[68:71], v[220:223], v[176:191]
    s_waitcnt vmcnt(14)
    v_mfma_f32_32x32x16_bf16 v[128:143], a[120:123], v[224:227], v[128:143]
    s_add_u32 s52, s73, 17408
    buffer_load_dwordx4 v[48:51], v2, s[40:43], s52 offen sc1
    v_mfma_f32_32x32x16_bf16 v[144:159], a[120:123], v[228:231], v[144:159]
    v_mfma_f32_32x32x16_bf16 v[160:175], a[124:127], v[224:227], v[160:175]
    s_add_u32 s52, s74, 17408
    buffer_load_dwordx4 v[52:55], v2, s[40:43], s52 offen sc1
    v_mfma_f32_32x32x16_bf16 v[176:191], a[124:127], v[228:231], v[176:191]
    s_waitcnt vmcnt(14)
    v_mfma_f32_32x32x16_bf16 v[128:143], a[176:179], v[232:235], v[128:143]
    s_add_u32 s52, s73, 24576
    buffer_load_dwordx4 v[56:59], v2, s[40:43], s52 offen sc1
    v_mfma_f32_32x32x16_bf16 v[144:159], a[176:179], v[236:239], v[144:159]
    v_mfma_f32_32x32x16_bf16 v[160:175], a[180:183], v[232:235], v[160:175]
    s_add_u32 s52, s74, 24576
    buffer_load_dwordx4 v[60:63], v2, s[40:43], s52 offen sc1
    v_mfma_f32_32x32x16_bf16 v[176:191], a[180:183], v[236:239], v[176:191]
    s_waitcnt vmcnt(14)
    v_mfma_f32_32x32x16_bf16 v[128:143], a[16:19], v[240:243], v[128:143]
    v_accvgpr_read_b32 v64, a232
    v_accvgpr_read_b32 v65, a233
    v_mfma_f32_32x32x16_bf16 v[144:159], a[16:19], v[244:247], v[144:159]
    v_accvgpr_read_b32 v66, a234
    v_accvgpr_read_b32 v67, a235
    v_mfma_f32_32x32x16_bf16 v[160:175], a[20:23], v[240:243], v[160:175]
    v_accvgpr_read_b32 v68, a236
    v_accvgpr_read_b32 v69, a237
    v_mfma_f32_32x32x16_bf16 v[176:191], a[20:23], v[244:247], v[176:191]
    v_accvgpr_read_b32 v70, a238
    v_accvgpr_read_b32 v71, a239
    s_waitcnt vmcnt(12)
    v_mfma_f32_32x32x16_bf16 v[128:143], a[72:75], v[248:251], v[128:143]
    v_lshlrev_b32 v72, 16, v64
    v_and_b32 v73, 0xffff0000, v64
    v_mfma_f32_32x32x16_bf16 v[144:159], a[72:75], v[252:255], v[144:159]
    v_lshlrev_b32 v74, 16, v65
    v_and_b32 v75, 0xffff0000, v65
    v_mfma_f32_32x32x16_bf16 v[160:175], a[76:79], v[248:251], v[160:175]
    v_lshlrev_b32 v76, 16, v66
    v_and_b32 v77, 0xffff0000, v66
    v_mfma_f32_32x32x16_bf16 v[176:191], a[76:79], v[252:255], v[176:191]
    v_lshlrev_b32 v78, 16, v67
    v_and_b32 v79, 0xffff0000, v67
    s_waitcnt vmcnt(10)
    v_mfma_f32_32x32x16_bf16 v[128:143], a[128:131], v[16:19], v[128:143]
    v_lshlrev_b32 v80, 16, v68
    v_and_b32 v81, 0xffff0000, v68
    v_mfma_f32_32x32x16_bf16 v[144:159], a[128:131], v[20:23], v[144:159]
    v_lshlrev_b32 v82, 16, v69
    v_and_b32 v83, 0xffff0000, v69
    v_mfma_f32_32x32x16_bf16 v[160:175], a[132:135], v[16:19], v[160:175]
    v_lshlrev_b32 v84, 16, v70
    v_and_b32 v85, 0xffff0000, v70
    v_mfma_f32_32x32x16_bf16 v[176:191], a[132:135], v[20:23], v[176:191]
    v_lshlrev_b32 v86, 16, v71
    v_and_b32 v87, 0xffff0000, v71
    s_waitcnt vmcnt(8)
    v_mfma_f32_32x32x16_bf16 v[128:143], a[184:187], v[24:27], v[128:143]
    s_xor_b32 s55, s50, 1
    s_mul_i32 s55, s55, 12288
    v_mfma_f32_32x32x16_bf16 v[144:159], a[184:187], v[28:31], v[144:159]
    s_add_u32 s55, s55, 98304
    v_add_u32 v4, s55, v2
    v_mfma_f32_32x32x16_bf16 v[160:175], a[188:191], v[24:27], v[160:175]
    s_xor_b32 s55, s50, 2
    s_mul_i32 s55, s55, 12288
    v_mfma_f32_32x32x16_bf16 v[176:191], a[188:191], v[28:31], v[176:191]
    s_add_u32 s55, s55, 102400
    v_add_u32 v5, s55, v2
    s_waitcnt vmcnt(6)
    v_mfma_f32_32x32x16_bf16 v[128:143], a[24:27], v[32:35], v[128:143]
    s_xor_b32 s55, s50, 3
    s_mul_i32 s55, s55, 12288
    v_mfma_f32_32x32x16_bf16 v[144:159], a[24:27], v[36:39], v[144:159]
    s_add_u32 s55, s55, 106496
    v_add_u32 v6, s55, v2
    v_mfma_f32_32x32x16_bf16 v[160:175], a[28:31], v[32:35], v[160:175]
    s_mul_i32 s55, s50, 12288
    s_add_u32 s55, s55, 98304
    v_mfma_f32_32x32x16_bf16 v[176:191], a[28:31], v[36:39], v[176:191]
    v_add_u32 v3, s55, v2
    v_and_b32 v8, 31, v1
    s_waitcnt vmcnt(4)
    v_mfma_f32_32x32x16_bf16 v[128:143], a[80:83], v[40:43], v[128:143]
    v_lshlrev_b32 v8, 10, v8
    v_lshrrev_b32 v9, 5, v1
    v_mfma_f32_32x32x16_bf16 v[144:159], a[80:83], v[44:47], v[144:159]
    v_lshlrev_b32 v9, 4, v9
    v_add_u32 v8, v8, v9
    v_mfma_f32_32x32x16_bf16 v[160:175], a[84:87], v[40:43], v[160:175]
    s_lshl_b32 s26, s64, 15
    s_lshl_b32 s27, s63, 6
    v_mfma_f32_32x32x16_bf16 v[176:191], a[84:87], v[44:47], v[176:191]
    s_add_u32 s26, s26, s27
    s_waitcnt vmcnt(2)
    v_mfma_f32_32x32x16_bf16 v[128:143], a[136:139], v[48:51], v[128:143]
    v_mfma_f32_32x32x16_bf16 v[144:159], a[136:139], v[52:55], v[144:159]
    v_mfma_f32_32x32x16_bf16 v[160:175], a[140:143], v[48:51], v[160:175]
    v_mfma_f32_32x32x16_bf16 v[176:191], a[140:143], v[52:55], v[176:191]
    s_waitcnt vmcnt(0)
    v_mfma_f32_32x32x16_bf16 v[128:143], a[192:195], v[56:59], v[128:143]
    v_mfma_f32_32x32x16_bf16 v[144:159], a[192:195], v[60:63], v[144:159]
    v_mfma_f32_32x32x16_bf16 v[160:175], a[196:199], v[56:59], v[160:175]
    v_mfma_f32_32x32x16_bf16 v[176:191], a[196:199], v[60:63], v[176:191]
L_g2_tail:
    s_nop 7
    s_nop 3
    ds_write_b128 v4, v[144:147] offset:0
    ds_write_b128 v4, v[148:151] offset:1024
    ds_write_b128 v4, v[152:155] offset:2048
    ds_write_b128 v4, v[156:159] offset:3072
    ds_write_b128 v5, v[160:163] offset:0
    ds_write_b128 v5, v[164:167] offset:1024
    ds_write_b128 v5, v[168:171] offset:2048
    ds_write_b128 v5, v[172:175] offset:3072
    ds_write_b128 v6, v[176:179] offset:0
    ds_write_b128 v6, v[180:183] offset:1024
    ds_write_b128 v6, v[184:187] offset:2048
    ds_write_b128 v6, v[188:191] offset:3072
    v_pk_add_f32 v[128:129], v[128:129], v[72:73]
    v_pk_add_f32 v[130:131], v[130:131], v[74:75]
    v_pk_add_f32 v[132:133], v[132:133], v[76:77]
    v_pk_add_f32 v[134:135], v[134:135], v[78:79]
    v_pk_add_f32 v[136:137], v[136:137], v[80:81]
    v_pk_add_f32 v[138:139], v[138:139], v[82:83]
    v_pk_add_f32 v[140:141], v[140:141], v[84:85]
    v_pk_add_f32 v[142:143], v[142:143], v[86:87]
    s_waitcnt lgkmcnt(0)
    s_barrier
    ds_read_b128 v[16:19], v3 offset:0
    ds_read_b128 v[20:23], v3 offset:1024
    ds_read_b128 v[24:27], v3 offset:2048
    ds_read_b128 v[28:31], v3 offset:3072
    ds_read_b128 v[32:35], v3 offset:4096
    ds_read_b128 v[36:39], v3 offset:5120
    ds_read_b128 v[40:43], v3 offset:6144
    ds_read_b128 v[44:47], v3 offset:7168
    ds_read_b128 v[48:51], v3 offset:8192
    ds_read_b128 v[52:55], v3 offset:9216
    ds_read_b128 v[56:59], v3 offset:10240
    ds_read_b128 v[60:63], v3 offset:11264
    s_waitcnt lgkmcnt(8)
    v_pk_add_f32 v[128:129], v[128:129], v[16:17]
    v_pk_add_f32 v[130:131], v[130:131], v[18:19]
    v_pk_add_f32 v[132:133], v[132:133], v[20:21]
    v_pk_add_f32 v[134:135], v[134:135], v[22:23]
    v_pk_add_f32 v[136:137], v[136:137], v[24:25]
    v_pk_add_f32 v[138:139], v[138:139], v[26:27]
    v_pk_add_f32 v[140:141], v[140:141], v[28:29]
    v_pk_add_f32 v[142:143], v[142:143], v[30:31]
    s_waitcnt lgkmcnt(4)
    v_pk_add_f32 v[128:129], v[128:129], v[32:33]
    v_pk_add_f32 v[130:131], v[130:131], v[34:35]
    v_pk_add_f32 v[132:133], v[132:133], v[36:37]
    v_pk_add_f32 v[134:135], v[134:135], v[38:39]
    v_pk_add_f32 v[136:137], v[136:137], v[40:41]
    v_pk_add_f32 v[138:139], v[138:139], v[42:43]
    v_pk_add_f32 v[140:141], v[140:141], v[44:45]
    v_pk_add_f32 v[142:143], v[142:143], v[46:47]
    s_waitcnt lgkmcnt(0)
    v_pk_add_f32 v[128:129], v[128:129], v[48:49]
    v_pk_add_f32 v[130:131], v[130:131], v[50:51]
    v_pk_add_f32 v[132:133], v[132:133], v[52:53]
    v_pk_add_f32 v[134:135], v[134:135], v[54:55]
    v_pk_add_f32 v[136:137], v[136:137], v[56:57]
    v_pk_add_f32 v[138:139], v[138:139], v[58:59]
    v_pk_add_f32 v[140:141], v[140:141], v[60:61]
    v_pk_add_f32 v[142:143], v[142:143], v[62:63]
    s_cmp_lg_u32 s67, 0
    s_cbranch_scc1 L_final
    v_pk_mul_f32 v[16:17], v[128:129], v[128:129]
    v_pk_mul_f32 v[18:19], v[130:131], v[130:131]
    v_pk_mul_f32 v[20:21], v[132:133], v[132:133]
    v_pk_mul_f32 v[22:23], v[134:135], v[134:135]
    v_pk_mul_f32 v[24:25], v[136:137], v[136:137]
    v_pk_mul_f32 v[26:27], v[138:139], v[138:139]
    v_pk_mul_f32 v[28:29], v[140:141], v[140:141]
    v_pk_mul_f32 v[30:31], v[142:143], v[142:143]
    v_pk_add_f32 v[32:33], v[128:129], v[130:131]
    v_pk_add_f32 v[34:35], v[132:133], v[134:135]
    v_pk_add_f32 v[36:37], v[136:137], v[138:139]
    v_pk_add_f32 v[38:39], v[140:141], v[142:143]
    v_pk_add_f32 v[16:17], v[16:17], v[18:19]
    v_pk_add_f32 v[20:21], v[20:21], v[22:23]
    v_pk_add_f32 v[24:25], v[24:25], v[26:27]
    v_pk_add_f32 v[28:29], v[28:29], v[30:31]
    v_pk_add_f32 v[32:33], v[32:33], v[34:35]
    v_pk_add_f32 v[36:37], v[36:37], v[38:39]
    v_pk_add_f32 v[16:17], v[16:17], v[20:21]
    v_pk_add_f32 v[24:25], v[24:25], v[28:29]
    v_pk_add_f32 v[32:33], v[32:33], v[36:37]
    v_pk_add_f32 v[16:17], v[16:17], v[24:25]
    v_add_f32 v8, v32, v33
    v_add_f32 v9, v16, v17
    v_mov_b32 v11, v8
    v_mov_b32 v12, v9
    v_lshlrev_b32 v2, 3, v1
    s_lshl_b32 s55, s63, 14
    s_lshl_b32 s56, s64, 8
    s_add_u32 s55, s55, s56
    v_permlane32_swap_b32 v8, v11
    v_permlane32_swap_b32 v9, v12
    s_add_u32 s56, s55, 10551296
    v_add_f32 v8, v8, v11
    v_add_f32 v9, v9, v12
    v_or_b32 v9, 1, v9
    s_mov_b64 exec, 0xffffffff
    buffer_store_dwordx2 v[8:9], v2, s[40:43], s56 offen sc1
    s_mov_b64 exec, -1
    s_mov_b32 s67, 1
    s_mov_b32 s68, 13172736
    s_mov_b32 s69, 22609920
    s_mov_b32 s70, 10551296
    s_mov_b32 s71, 10813440
    s_mov_b32 s79, 208
    s_branch L_layer
L_final:
    v_cvt_pk_bf16_f32 v16, v128, v129
    v_cvt_pk_bf16_f32 v17, v130, v131
    v_cvt_pk_bf16_f32 v18, v132, v133
    v_cvt_pk_bf16_f32 v19, v134, v135
    buffer_store_dwordx4 v[16:19], v8, s[36:39], s26 offen
    v_cvt_pk_bf16_f32 v20, v136, v137
    v_cvt_pk_bf16_f32 v21, v138, v139
    v_cvt_pk_bf16_f32 v22, v140, v141
    v_cvt_pk_bf16_f32 v23, v142, v143
    buffer_store_dwordx4 v[20:23], v8, s[36:39], s26 offen offset:32
L_end:
    s_endpgm
L_rt_36:
    s_mov_b32 s60, 0
L_rl_38:
    s_add_u32 s52, s78, 0
    buffer_load_dwordx4 v[16:19], v2, s[40:43], s52 offen offset:0 sc1
    buffer_load_dwordx4 v[20:23], v2, s[40:43], s52 offen offset:1024 sc1
    buffer_load_dwordx4 v[24:27], v2, s[40:43], s52 offen offset:2048 sc1
    buffer_load_dwordx4 v[28:31], v2, s[40:43], s52 offen offset:3072 sc1
    s_waitcnt vmcnt(0)
    v_max3_u32 v7, v16, v17, v18
    v_max3_u32 v7, v7, v19, v20
    v_max3_u32 v7, v7, v21, v22
    v_max3_u32 v7, v7, v23, v24
    v_max3_u32 v7, v7, v25, v26
    v_max3_u32 v7, v7, v27, v28
    v_max3_u32 v7, v7, v29, v30
    v_max_u32 v7, v7, v31
    v_cmp_eq_u32 vcc, -1, v7
    s_add_u32 s60, s60, 1
    s_nop 1
    s_cbranch_vccz L_bk_37
    s_cmp_lt_u32 s60, 20000
    s_cbranch_scc1 L_rl_38
    s_branch L_bk_37
L_rt_39:
    s_mov_b32 s60, 0
L_rl_41:
    s_add_u32 s52, s78, 4096
    buffer_load_dwordx4 v[32:35], v2, s[40:43], s52 offen offset:0 sc1
    buffer_load_dwordx4 v[36:39], v2, s[40:43], s52 offen offset:1024 sc1
    buffer_load_dwordx4 v[40:43], v2, s[40:43], s52 offen offset:2048 sc1
    buffer_load_dwordx4 v[44:47], v2, s[40:43], s52 offen offset:3072 sc1
    s_waitcnt vmcnt(0)
    v_max3_u32 v7, v32, v33, v34
    v_max3_u32 v7, v7, v35, v36
    v_max3_u32 v7, v7, v37, v38
    v_max3_u32 v7, v7, v39, v40
    v_max3_u32 v7, v7, v41, v42
    v_max3_u32 v7, v7, v43, v44
    v_max3_u32 v7, v7, v45, v46
    v_max_u32 v7, v7, v47
    v_cmp_eq_u32 vcc, -1, v7
    s_add_u32 s60, s60, 1
    s_nop 1
    s_cbranch_vccz L_bk_40
    s_cmp_lt_u32 s60, 20000
    s_cbranch_scc1 L_rl_41
    s_branch L_bk_40
L_rt_42:
    s_mov_b32 s60, 0
L_rl_44:
    v_and_b32 v3, 31, v1
    v_lshlrev_b32 v3, 3, v3
    v_lshrrev_b32 v7, 5, v1
    v_lshlrev_b32 v7, 17, v7
    v_add_u32 v3, v3, v7
    s_lshl_b32 s52, s72, 8
    s_add_u32 s52, s52, s71
    s_add_u32 s53, s52, 0
    buffer_load_dwordx2 v[192:193], v3, s[40:43], s53 offen sc1
    s_add_u32 s53, s52, 16384
    buffer_load_dwordx2 v[194:195], v3, s[40:43], s53 offen sc1
    s_add_u32 s53, s52, 32768
    buffer_load_dwordx2 v[196:197], v3, s[40:43], s53 offen sc1
    s_add_u32 s53, s52, 49152
    buffer_load_dwordx2 v[198:199], v3, s[40:43], s53 offen sc1
    s_add_u32 s53, s52, 65536
    buffer_load_dwordx2 v[200:201], v3, s[40:43], s53 offen sc1
    s_add_u32 s53, s52, 81920
    buffer_load_dwordx2 v[202:203], v3, s[40:43], s53 offen sc1
    s_add_u32 s53, s52, 98304
    buffer_load_dwordx2 v[204:205], v3, s[40:43], s53 offen sc1
    s_add_u32 s53, s52, 114688
    buffer_load_dwordx2 v[206:207], v3, s[40:43], s53 offen sc1
    s_waitcnt vmcnt(0)
    v_and_b32 v7, v193, v195
    v_and_b32 v7, v7, v197
    v_and_b32 v7, v7, v199
    v_and_b32 v7, v7, v201
    v_and_b32 v7, v7, v203
    v_and_b32 v7, v7, v205
    v_and_b32 v7, v7, v207
    v_and_b32 v7, 1, v7
    v_cmp_ne_u32 vcc, 1, v7
    s_add_u32 s60, s60, 1
    s_nop 1
    s_cbranch_vccz L_bk_43
    s_cmp_lt_u32 s60, 20000
    s_cbranch_scc1 L_rl_44
    s_branch L_bk_43
L_rt_45:
    s_mov_b32 s60, 0
L_rl_47:
    s_add_u32 s52, s78, 8192
    buffer_load_dwordx4 v[48:51], v2, s[40:43], s52 offen offset:0 sc1
    buffer_load_dwordx4 v[52:55], v2, s[40:43], s52 offen offset:1024 sc1
    buffer_load_dwordx4 v[56:59], v2, s[40:43], s52 offen offset:2048 sc1
    buffer_load_dwordx4 v[60:63], v2, s[40:43], s52 offen offset:3072 sc1
    s_waitcnt vmcnt(0)
    v_max3_u32 v7, v48, v49, v50
    v_max3_u32 v7, v7, v51, v52
    v_max3_u32 v7, v7, v53, v54
    v_max3_u32 v7, v7, v55, v56
    v_max3_u32 v7, v7, v57, v58
    v_max3_u32 v7, v7, v59, v60
    v_max3_u32 v7, v7, v61, v62
    v_max_u32 v7, v7, v63
    v_cmp_eq_u32 vcc, -1, v7
    s_add_u32 s60, s60, 1
    s_nop 1
    s_cbranch_vccz L_bk_46
    s_cmp_lt_u32 s60, 20000
    s_cbranch_scc1 L_rl_47
    s_branch L_bk_46
L_rt_48:
    s_mov_b32 s60, 0
L_rl_50:
    s_add_u32 s52, s78, 12288
    buffer_load_dwordx4 v[64:67], v2, s[40:43], s52 offen offset:0 sc1
    buffer_load_dwordx4 v[68:71], v2, s[40:43], s52 offen offset:1024 sc1
    buffer_load_dwordx4 v[72:75], v2, s[40:43], s52 offen offset:2048 sc1
    buffer_load_dwordx4 v[76:79], v2, s[40:43], s52 offen offset:3072 sc1
    s_waitcnt vmcnt(0)
    v_max3_u32 v7, v64, v65, v66
    v_max3_u32 v7, v7, v67, v68
    v_max3_u32 v7, v7, v69, v70
    v_max3_u32 v7, v7, v71, v72
    v_max3_u32 v7, v7, v73, v74
    v_max3_u32 v7, v7, v75, v76
    v_max3_u32 v7, v7, v77, v78
    v_max_u32 v7, v7, v79
    v_cmp_eq_u32 vcc, -1, v7
    s_add_u32 s60, s60, 1
    s_nop 1
    s_cbranch_vccz L_bk_49
    s_cmp_lt_u32 s60, 20000
    s_cbranch_scc1 L_rl_50
    s_branch L_bk_49
L_rt_51:
    s_mov_b32 s60, 0
L_rl_53:
    s_add_u32 s52, s78, 16384
    buffer_load_dwordx4 v[80:83], v2, s[40:43], s52 offen offset:0 sc1
    buffer_load_dwordx4 v[84:87], v2, s[40:43], s52 offen offset:1024 sc1
    buffer_load_dwordx4 v[88:91], v2, s[40:43], s52 offen offset:2048 sc1
    buffer_load_dwordx4 v[92:95], v2, s[40:43], s52 offen offset:3072 sc1
    s_waitcnt vmcnt(0)
    v_max3_u32 v7, v80, v81, v82
    v_max3_u32 v7, v7, v83, v84
    v_max3_u32 v7, v7, v85, v86
    v_max3_u32 v7, v7, v87, v88
    v_max3_u32 v7, v7, v89, v90
    v_max3_u32 v7, v7, v91, v92
    v_max3_u32 v7, v7, v93, v94
    v_max_u32 v7, v7, v95
    v_cmp_eq_u32 vcc, -1, v7
    s_add_u32 s60, s60, 1
    s_nop 1
    s_cbranch_vccz L_bk_52
    s_cmp_lt_u32 s60, 20000
    s_cbranch_scc1 L_rl_53
    s_branch L_bk_52
L_rt_54:
    s_mov_b32 s60, 0
L_rl_56:
    s_add_u32 s52, s78, 20480
    buffer_load_dwordx4 v[96:99], v2, s[40:43], s52 offen offset:0 sc1
    buffer_load_dwordx4 v[100:103], v2, s[40:43], s52 offen offset:1024 sc1
    buffer_load_dwordx4 v[104:107], v2, s[40:43], s52 offen offset:2048 sc1
    buffer_load_dwordx4 v[108:111], v2, s[40:43], s52 offen offset:3072 sc1
    s_waitcnt vmcnt(0)
    v_max3_u32 v7, v96, v97, v98
    v_max3_u32 v7, v7, v99, v100
    v_max3_u32 v7, v7, v101, v102
    v_max3_u32 v7, v7, v103, v104
    v_max3_u32 v7, v7, v105, v106
    v_max3_u32 v7, v7, v107, v108
    v_max3_u32 v7, v7, v109, v110
    v_max_u32 v7, v7, v111
    v_cmp_eq_u32 vcc, -1, v7
    s_add_u32 s60, s60, 1
    s_nop 1
    s_cbranch_vccz L_bk_55
    s_cmp_lt_u32 s60, 20000
    s_cbranch_scc1 L_rl_56
    s_branch L_bk_55
L_rt_57:
    s_mov_b32 s60, 0
L_rl_59:
    s_add_u32 s52, s78, 24576
    buffer_load_dwordx4 v[112:115], v2, s[40:43], s52 offen offset:0 sc1
    buffer_load_dwordx4 v[116:119], v2, s[40:43], s52 offen offset:1024 sc1
    buffer_load_dwordx4 v[120:123], v2, s[40:43], s52 offen offset:2048 sc1
    buffer_load_dwordx4 v[124:127], v2, s[40:43], s52 offen offset:3072 sc1
    s_waitcnt vmcnt(0)
    v_max3_u32 v7, v112, v113, v114
    v_max3_u32 v7, v7, v115, v116
    v_max3_u32 v7, v7, v117, v118
    v_max3_u32 v7, v7, v119, v120
    v_max3_u32 v7, v7, v121, v122
    v_max3_u32 v7, v7, v123, v124
    v_max3_u32 v7, v7, v125, v126
    v_max_u32 v7, v7, v127
    v_cmp_eq_u32 vcc, -1, v7
    s_add_u32 s60, s60, 1
    s_nop 1
    s_cbranch_vccz L_bk_58
    s_cmp_lt_u32 s60, 20000
    s_cbranch_scc1 L_rl_59
    s_branch L_bk_58
L_rt_60:
    s_mov_b32 s60, 0
L_rl_62:
    s_add_u32 s52, s78, 28672
    buffer_load_dwordx4 v[128:131], v2, s[40:43], s52 offen offset:0 sc1
    buffer_load_dwordx4 v[132:135], v2, s[40:43], s52 offen offset:1024 sc1
    buffer_load_dwordx4 v[136:139], v2, s[40:43], s52 offen offset:2048 sc1
    buffer_load_dwordx4 v[140:143], v2, s[40:43], s52 offen offset:3072 sc1
    s_waitcnt vmcnt(0)
    v_max3_u32 v7, v128, v129, v130
    v_max3_u32 v7, v7, v131, v132
    v_max3_u32 v7, v7, v133, v134
    v_max3_u32 v7, v7, v135, v136
    v_max3_u32 v7, v7, v137, v138
    v_max3_u32 v7, v7, v139, v140
    v_max3_u32 v7, v7, v141, v142
    v_max_u32 v7, v7, v143
    v_cmp_eq_u32 vcc, -1, v7
    s_add_u32 s60, s60, 1
    s_nop 1
    s_cbranch_vccz L_bk_61
    s_cmp_lt_u32 s60, 20000
    s_cbranch_scc1 L_rl_62
    s_branch L_bk_61
    s_endpgm
L_code_end:
.section .rodata,"a"
.p2align 6
.amdhsa_kernel interleave_layers__ssm_conv_h3__glu_gated_geglu__prompt_kernel
  .amdhsa_next_free_vgpr 512
  .amdhsa_next_free_sgpr 102
  .amdhsa_accum_offset 256
  .amdhsa_group_segment_fixed_size 0
  .amdhsa_kernarg_size 104
  .amdhsa_user_sgpr_count 2
  .amdhsa_user_sgpr_kernarg_segment_ptr 1
  .amdhsa_system_sgpr_workgroup_id_x 1
  .amdhsa_float_denorm_mode_32 3
.end_amdhsa_kernel
```
